```python
import torch

def _softmax(x, axis=-1):
    return torch.softmax(x, dim=axis)

def _gelu(x):
    return torch.nn.functional.gelu(x, approximate='tanh')

def _silu(x):
    return torch.nn.functional.silu(x)

def _sigmoid(x):
    return torch.sigmoid(x)

def _layernorm(x, axis=-1, eps=1e-05):
    m = x.mean(dim=axis, keepdim=True)
    v = x.var(dim=axis, keepdim=True, unbiased=False)
    return (x - m) / torch.sqrt(v + eps)

def _scatter_add(tgt, idx, src, axis=0):
    return tgt.clone().index_add_(axis, idx, src)

def _segment_sum(src, seg, n):
    out = torch.zeros((n,) + src.shape[1:], dtype=src.dtype)
    return out.index_add_(0, seg, src)

def _pad(x, pw):
    flat = tuple((v for pair in reversed(pw) for v in pair))
    return torch.nn.functional.pad(x, flat)
kernel_name = 'adaLN_cond__sliding_block_cached__glu_gated_swiglu__decode'

def setup_inputs():

    _w = lambda a: (lambda t: t.to(torch.bfloat16) if t.is_floating_point() else t)(torch.as_tensor(a))

    def _A_setup():
        B, Sq, D = (8, 1, 448)
        Hq, Hkv, Sk, Dh = (16, 8, 8192, 256)
        assert Hq % Hkv == 0, (Hq, Hkv)
        return {'x': _w((lambda *s: torch.randn(*s, dtype=torch.bfloat16) * 0.05)(B, Sq, D)), 'k_cache': _w((lambda *s: torch.randn(*s, dtype=torch.bfloat16) * 0.8)(B, Hkv, Sk, Dh)), 'v_cache': _w((lambda *s: torch.randn(*s, dtype=torch.bfloat16) * 3.2)(B, Hkv, Sk, Dh)), 'wq': _w((lambda *s: torch.randn(*s, dtype=torch.bfloat16) * 0.8)(D, Hq * Dh) * D ** (-0.5)), 'wo': _w((lambda *s: torch.randn(*s, dtype=torch.bfloat16) * 3.2)(Hq * Dh, D) * (Hq * Dh) ** (-0.5))}
    _A_in = _A_setup()

    def _B_setup():
        B, S, D, F = (8, 1, 448, 1792)
        return {'x': _w((lambda *s: torch.randn(*s, dtype=torch.bfloat16) * 0.05)(B, S, D)), 'w1': _w((lambda *s: torch.randn(*s, dtype=torch.bfloat16) * 1.6)(D, F) * (2.0 / D) ** 0.5), 'w3': _w((lambda *s: torch.randn(*s, dtype=torch.bfloat16) * 1.6)(D, F) * (2.0 / D) ** 0.5), 'w2': _w((lambda *s: torch.randn(*s, dtype=torch.bfloat16) * 1.6)(F, D) * (2.0 / F) ** 0.5)}
    _B_in = _B_setup()
    return {'A_x': _A_in['x'], 'A_k_cache': _A_in['k_cache'], 'A_v_cache': _A_in['v_cache'], 'A_wq': _A_in['wq'], 'A_wo': _A_in['wo'], 'B_x': _B_in['x'], 'B_w1': _B_in['w1'], 'B_w3': _B_in['w3'], 'B_w2': _B_in['w2'], 'c': _w((lambda *s: torch.randn(*s, dtype=torch.bfloat16) * 0.4)(8, 448) * 8.0), 'w_mod': _w((lambda *s: torch.randn(*s, dtype=torch.bfloat16) * 0.4)(448, 6 * 448) * 448 ** (-0.5) * 8.0)}

def reference(A_x, A_k_cache, A_v_cache, A_wq, A_wo, B_x, B_w1, B_w3, B_w2, c, w_mod):

    def _A_ref(x, k_cache, v_cache, wq, wo):
        B, Sq, D = x.shape
        Hq, Dh = (16, 256)
        Hkv, Sk = (k_cache.shape[1], k_cache.shape[2])
        W = min(4096, max(256, Sk // 4))
        rep = Hq // Hkv
        q = (lambda x, *d: x.permute(*d))((x @ wq).reshape(B, Sq, Hq, Dh), 0, 2, 1, 3)
        k = (lambda x, n, axis: torch.repeat_interleave(x, n, dim=axis))(k_cache[:, :, Sk - W:, :], rep, axis=1)
        v = (lambda x, n, axis: torch.repeat_interleave(x, n, dim=axis))(v_cache[:, :, Sk - W:, :], rep, axis=1)
        scores = torch.einsum('bhqd,bhkd->bhqk', q, k) * Dh ** (-0.5)
        p = _softmax(scores, axis=-1)
        o = torch.einsum('bhqk,bhkd->bhqd', p, v)
        return (lambda x, *d: x.permute(*d))(o, 0, 2, 1, 3).reshape(B, Sq, Hq * Dh) @ wo

    def _B_ref(x, w1, w3, w2):
        gate = torch.einsum('bsd,df->bsf', x, w1)
        up = torch.einsum('bsd,df->bsf', x, w3)
        h = _silu(gate) * up
        out = torch.einsum('bsf,fd->bsd', h, w2)
        return out
    x = A_x
    mod = (_silu(c) @ w_mod).reshape(c.shape[0], 6, 1, -1)
    sa, ca, ga, sb, cb, gb = (mod[:, 0].clone(), mod[:, 1].clone(), mod[:, 2].clone(), mod[:, 3].clone(), mod[:, 4].clone(), mod[:, 5].clone())
    h = _layernorm(x, axis=-1) * (1 + ca) + sa
    x = x + ga * _A_ref(h, A_k_cache, A_v_cache, A_wq, A_wo)
    h = _layernorm(x, axis=-1) * (1 + cb) + sb
    x = x + gb * _B_ref(h, B_w1, B_w3, B_w2)
    return x
```

```asm
; @launch grid=(256,1,1) block=(512,1,1) lds=162816
.amdgcn_target "amdgcn-amd-amdhsa--gfx950"
.text
.globl adaLN_cond__sliding_block_cached__glu_gated_swiglu__decode_kernel
.p2align 8
.type adaLN_cond__sliding_block_cached__glu_gated_swiglu__decode_kernel,@function
adaLN_cond__sliding_block_cached__glu_gated_swiglu__decode_kernel:
    s_load_dwordx16 s[40:55], s[0:1], 0
    s_load_dwordx8 s[56:63], s[0:1], 64
    s_load_dwordx4 s[64:67], s[0:1], 96
    v_lshrrev_b32 v1, 6, v0
    s_lshr_b32 s5, s2, 5
    s_cmp_ge_u32 s5, 8
    s_cbranch_scc1 L_end
    v_readfirstlane_b32 s3, v1
    v_and_b32 v0, 63, v0
    s_and_b32 s4, s2, 7
    s_lshr_b32 s7, s2, 3
    s_and_b32 s6, s7, 3
    s_lshl_b32 s30, s5, 1
    s_lshr_b32 s74, 0xcaa0, s30
    s_and_b32 s74, s74, 3
    s_and_b32 s30, s2, 0xe7
    s_cmpk_eq_u32 s30, 0xe0
    s_cselect_b32 s74, 0, s74
    s_cmp_lt_u32 s2, 42
    s_cselect_b32 s74, 1, s74
    s_cmp_ge_u32 s3, 4
    s_cbranch_scc1 L_cstub
    v_and_b32 v4, 7, v0
    v_and_b32 v5, 48, v0
    v_lshl_or_b32 v1, v4, 9, v5
    v_and_b32 v5, 8, v0
    v_lshl_or_b32 v1, v5, 3, v1
    s_lshl3_add_u32 s32, s5, s4
    s_lshl2_add_u32 s32, s32, 3
    s_lshl_b32 s32, s32, 20
    s_lshl_b32 s37, s6, 15
    s_brev_b32 s31, s3
    s_lshr_b32 s31, s31, 18
    s_or_b32 s36, s37, s31
    s_mov_b32 s10, 0x100000
    s_mov_b32 s11, 0x20000
    s_bitcmp1_b32 14, s74
    s_cselect_b64 vcc, -1, 0
    s_cbranch_scc1 L_role
    s_waitcnt lgkmcnt(0)
L_k0:
    s_add_u32 s8, s42, s32
    s_addc_u32 s9, s43, 0
    buffer_load_dwordx4 v[32:35], v1, s[8:11], s36 offen offset:0 nt
    buffer_load_dwordx4 v[36:39], v1, s[8:11], s36 offen offset:128 nt
    buffer_load_dwordx4 v[40:43], v1, s[8:11], s36 offen offset:256 nt
    buffer_load_dwordx4 v[44:47], v1, s[8:11], s36 offen offset:384 nt
    s_branch L_k4
L_cstub:
    v_mov_b32 v4, 0
    v_mov_b32 v5, 0
    v_mov_b32 v6, 0
    v_mov_b32 v7, 0
    v_lshlrev_b32 v8, 4, v0
    ds_write_b128 v8, v[4:7]
    s_waitcnt lgkmcnt(0)
    s_barrier
    s_branch L_chain
L_role:
    s_lshl2_add_u32 s34, s4, s6
    s_and_b32 s29, s3, 3
    s_and_b32 s31, s7, 7
    s_lshl3_add_u32 s30, s4, s31
    s_cmp_lt_u32 s2, 42
    s_cselect_b32 s30, s2, s30
    v_bfe_u32 v6, v0, 1, 3
    v_lshrrev_b32 v10, 4, v0
    v_and_b32 v11, 1, v0
    v_lshlrev_b32 v11, 4, v11
    v_lshl_or_b32 v7, v10, 5, v11
    s_movk_i32 s26, 896
    s_mov_b32 s22, 1605632
    s_and_b32 s31, s5, 4
    s_lshl_b32 s31, s31, 12
    s_add_u32 s30, s30, s31
    s_sub_u32 s31, s34, 4
    s_mulk_i32 s31, 448
    s_waitcnt lgkmcnt(0)
    s_load_dword s24, s[42:43], s32
    s_cmp_eq_u32 s74, 1
    s_cmovk_i32 s26, 5376
    s_cmov_b32 s22, 2408448
    s_cselect_b64 s[20:21], s[60:61], s[56:57]
    s_cmp_eq_u32 s74, 2
    s_cmovk_i32 s26, 8192
    s_cmov_b32 s22, 3670016
    s_cselect_b64 s[20:21], s[46:47], s[20:21]
    s_lshl_b32 s68, s26, 3
    s_lshl_b32 s69, s26, 6
    s_cmp_eq_u32 s74, 3
    s_cmovk_i32 s69, 128
    s_cselect_b32 s30, s31, s30
    s_lshl_b32 s70, s30, 7
    s_mov_b32 s23, 0x20000
    v_mad_u32_u24 v9, v6, s26, v7
    s_lshl_b32 s30, s29, 1
    s_mul_i32 s31, s30, 1152
    s_add_u32 m0, s31, 16384
    s_mul_i32 s30, s30, s68
    s_add_u32 s30, s30, s70
    s_add_u32 s31, s30, s68
    buffer_load_dwordx4 v9, s[20:23], s30 offen nt lds
    s_addk_i32 m0, 1152
    s_add_u32 s30, s30, s69
    buffer_load_dwordx4 v9, s[20:23], s31 offen nt lds
    s_addk_i32 m0, 8064
    s_add_u32 s31, s31, s69
    buffer_load_dwordx4 v9, s[20:23], s30 offen nt lds
    s_addk_i32 m0, 1152
    s_add_u32 s30, s30, s69
    buffer_load_dwordx4 v9, s[20:23], s31 offen nt lds
    s_addk_i32 m0, 8064
    s_add_u32 s31, s31, s69
    buffer_load_dwordx4 v9, s[20:23], s30 offen nt lds
    s_addk_i32 m0, 1152
    s_add_u32 s30, s30, s69
    buffer_load_dwordx4 v9, s[20:23], s31 offen nt lds
    s_addk_i32 m0, 8064
    s_add_u32 s31, s31, s69
    buffer_load_dwordx4 v9, s[20:23], s30 offen nt lds
    s_addk_i32 m0, 1152
    s_add_u32 s30, s30, s69
    buffer_load_dwordx4 v9, s[20:23], s31 offen nt lds
    s_addk_i32 m0, 8064
    s_add_u32 s31, s31, s69
    s_barrier
    s_cmp_eq_u32 s74, 2
    s_cbranch_scc1 L_k0
    buffer_load_dwordx4 v9, s[20:23], s30 offen nt lds
    s_addk_i32 m0, 1152
    s_add_u32 s30, s30, s69
    buffer_load_dwordx4 v9, s[20:23], s31 offen nt lds
    s_addk_i32 m0, 8064
    s_add_u32 s31, s31, s69
    buffer_load_dwordx4 v9, s[20:23], s30 offen nt lds
    s_addk_i32 m0, 1152
    s_add_u32 s30, s30, s69
    buffer_load_dwordx4 v9, s[20:23], s31 offen nt lds
    s_addk_i32 m0, 8064
    s_add_u32 s31, s31, s69
    buffer_load_dwordx4 v9, s[20:23], s30 offen nt lds
    s_addk_i32 m0, 1152
    s_add_u32 s30, s30, s69
    buffer_load_dwordx4 v9, s[20:23], s31 offen nt lds
    s_branch L_k0
L_k4:
    s_mov_b32 s33, 0
    s_lshl_b32 s27, s3, 14
    s_add_u32 s27, s27, 80896
    s_xor_b32 s36, s36, 16384
    s_add_u32 m0, s27, 0
    s_nop 0
    buffer_load_dwordx4 v1, s[8:11], s36 offen offset:0 nt lds
    s_cbranch_vccnz L_nb
    s_barrier
L_nb:
    s_cbranch_vccnz L_dp_1
    s_waitcnt vmcnt(4)
L_dp_1:
    s_add_u32 m0, s27, 896
    s_nop 0
    buffer_load_dwordx4 v1, s[8:11], s36 offen offset:128 nt lds
    s_cbranch_vccnz L_dp_2
    s_waitcnt vmcnt(4)
L_dp_2:
    s_cbranch_vccz L_df_3
    s_waitcnt vmcnt(6)
L_df_3:
    v_mov_b32 v4, 0
    v_mov_b32 v5, 1
    s_mov_b64 exec, 1
    ds_add_u32 v4, v5 offset:24
    s_mov_b64 exec, -1
    s_add_u32 m0, s27, 1792
    s_nop 0
    buffer_load_dwordx4 v1, s[8:11], s36 offen offset:256 nt lds
    s_cbranch_vccnz L_dp_4
    s_waitcnt vmcnt(4)
L_dp_4:
    s_add_u32 m0, s27, 2688
    s_nop 0
    buffer_load_dwordx4 v1, s[8:11], s36 offen offset:384 nt lds
    s_waitcnt vmcnt(7)
    s_cbranch_vccnz L_dp_5
    s_waitcnt vmcnt(4)
L_dp_5:
    s_xor_b32 s36, s36, 147456
    s_add_u32 m0, s27, 4096
    s_nop 0
    buffer_load_dwordx4 v1, s[8:11], s36 offen offset:0 nt lds
    v_and_b32 v4, 7, v0
    v_lshrrev_b32 v5, 3, v0
    v_lshlrev_b32 v4, 4, v4
    v_lshl_or_b32 v2, v5, 9, v4
    s_lshl_b32 s31, s3, 7
    s_or_b32 s37, s37, s31
    s_add_u32 s12, s44, s32
    s_addc_u32 s13, s45, 0
    s_mov_b32 s14, 0x100000
    s_mov_b32 s15, 0x20000
    s_mov_b32 s16, s66
    s_mov_b32 s17, s67
    s_mov_b32 s18, 4194304
    s_mov_b32 s19, 0x20000
    s_mov_b32 s38, 0x05040100
    s_mov_b32 s39, 0x07060302
    s_load_dword s58, s[66:67], 0
    s_and_b32 s57, s7, 1
    s_lshl1_add_u32 s56, s4, s57
    s_lshl_b32 s56, s56, 9
    s_add_u32 s56, s56, 335872
    s_lshr_b32 s57, s7, 1
    s_lshl2_add_u32 s57, s57, s3
    s_lshl1_add_u32 s57, s57, s56
    s_xor_b32 s56, s56, 512
    s_cmp_eq_u32 s4, 0
    s_cselect_b32 s59, 42, 52
    s_cselect_b32 s63, 12, 22
    s_cmp_eq_u32 s74, 3
    s_cselect_b32 s59, 0, s59
    s_waitcnt vmcnt(7)
    s_cbranch_vccnz L_dp_6
    s_waitcnt vmcnt(4)
L_dp_6:
    s_add_u32 m0, s27, 4992
    s_nop 0
    buffer_load_dwordx4 v1, s[8:11], s36 offen offset:128 nt lds
    s_waitcnt vmcnt(7)
    s_cbranch_vccnz L_dp_7
    s_waitcnt vmcnt(4)
L_dp_7:
    s_add_u32 m0, s27, 5888
    s_nop 0
    buffer_load_dwordx4 v1, s[8:11], s36 offen offset:256 nt lds
    s_waitcnt vmcnt(7)
    s_cbranch_vccnz L_dp_8
    s_waitcnt vmcnt(4)
L_dp_8:
    s_add_u32 m0, s27, 6784
    s_nop 0
    buffer_load_dwordx4 v1, s[8:11], s36 offen offset:384 nt lds
    s_waitcnt vmcnt(7)
    s_cbranch_vccnz L_dp_9
    s_waitcnt vmcnt(4)
L_dp_9:
    s_xor_b32 s36, s36, 16384
    s_add_u32 m0, s27, 8192
    s_nop 0
    buffer_load_dwordx4 v1, s[8:11], s36 offen offset:0 nt lds
    s_waitcnt vmcnt(7)
    s_cbranch_vccnz L_dp_10
    s_waitcnt vmcnt(4)
L_dp_10:
    s_add_u32 m0, s27, 9088
    s_nop 0
    buffer_load_dwordx4 v1, s[8:11], s36 offen offset:128 nt lds
    s_waitcnt vmcnt(7)
    s_cbranch_vccnz L_dp_11
    s_waitcnt vmcnt(4)
L_dp_11:
    s_add_u32 m0, s27, 9984
    s_nop 0
    buffer_load_dwordx4 v1, s[8:11], s36 offen offset:256 nt lds
    s_waitcnt vmcnt(7)
    s_cbranch_vccnz L_dp_12
    s_waitcnt vmcnt(4)
L_dp_12:
    s_add_u32 m0, s27, 10880
    s_nop 0
    buffer_load_dwordx4 v1, s[8:11], s36 offen offset:384 nt lds
    s_waitcnt vmcnt(7)
    s_cbranch_vccnz L_dp_13
    s_waitcnt vmcnt(4)
L_dp_13:
    s_xor_b32 s36, s36, 409600
    s_add_u32 m0, s27, 12288
    s_nop 0
    buffer_load_dwordx4 v1, s[8:11], s36 offen offset:0 nt lds
    s_waitcnt lgkmcnt(0)
    s_add_u32 s58, s58, 1
    s_lshl_b32 s58, s58, 4
    s_and_b32 s58, s58, 0xffff
    v_lshlrev_b32 v7, 1, v0
    s_add_u32 s60, s58, 1
    v_mov_b32 v4, s60
    buffer_load_ushort v7, v7, s[16:19], s56 offen sc1
    s_mov_b64 exec, 1
    buffer_store_short v4, off, s[16:19], s57
    s_mov_b64 exec, -1
    s_waitcnt vmcnt(9)
    s_cbranch_vccnz L_dp_14
    s_waitcnt vmcnt(6)
L_dp_14:
    s_add_u32 m0, s27, 13184
    s_nop 0
    buffer_load_dwordx4 v1, s[8:11], s36 offen offset:128 nt lds
    s_waitcnt vmcnt(9)
    s_cbranch_vccnz L_dp_15
    s_waitcnt vmcnt(6)
L_dp_15:
    s_add_u32 m0, s27, 14080
    s_nop 0
    buffer_load_dwordx4 v1, s[8:11], s36 offen offset:256 nt lds
    s_waitcnt vmcnt(9)
    s_cbranch_vccnz L_dp_16
    s_waitcnt vmcnt(6)
L_dp_16:
    s_add_u32 m0, s27, 14976
    s_nop 0
    buffer_load_dwordx4 v1, s[8:11], s36 offen offset:384 nt lds
    s_waitcnt vmcnt(9)
    s_cbranch_vccnz L_dp_17
    s_waitcnt vmcnt(6)
L_dp_17:
    s_xor_b32 s36, s36, 16384
    buffer_load_dwordx4 v[48:51], v1, s[8:11], s36 offen offset:0 nt
    s_waitcnt vmcnt(9)
    s_cbranch_vccnz L_dp_18
    s_waitcnt vmcnt(6)
L_dp_18:
    buffer_load_dwordx4 v[52:55], v1, s[8:11], s36 offen offset:128 nt
    s_waitcnt vmcnt(9)
    s_cbranch_vccnz L_dp_19
    s_waitcnt vmcnt(4)
L_dp_19:
    buffer_load_dwordx4 v[56:59], v1, s[8:11], s36 offen offset:256 nt
    s_waitcnt vmcnt(9)
    s_cbranch_vccnz L_dp_20
    s_waitcnt vmcnt(4)
L_dp_20:
    buffer_load_dwordx4 v[60:63], v1, s[8:11], s36 offen offset:384 nt
    s_waitcnt vmcnt(9)
    s_cbranch_vccnz L_dp_21
    s_waitcnt vmcnt(4)
L_dp_21:
    s_xor_b32 s36, s36, 147456
    buffer_load_dwordx4 v[64:67], v1, s[8:11], s36 offen offset:0 nt
    s_waitcnt vmcnt(7)
    s_add_u32 s60, s58, 1
    v_subrev_u32 v7, s60, v7
    v_cmp_gt_u32 vcc, 15, v7
    s_bcnt1_i32_b64 s62, vcc
    s_cmp_ge_u32 s62, s59
    s_cselect_b64 vcc, -1, 0
    s_cbranch_vccnz L_dp_22
    s_waitcnt vmcnt(5)
    s_cmp_ge_u32 s62, s63
    s_cbranch_scc1 L_dp_22
    s_waitcnt vmcnt(4)
L_dp_22:
    buffer_load_dwordx4 v[68:71], v1, s[8:11], s36 offen offset:128 nt
    s_waitcnt vmcnt(7)
    s_cbranch_vccnz L_dp_23
    s_waitcnt vmcnt(5)
    s_cmp_ge_u32 s62, s63
    s_cbranch_scc1 L_dp_23
    s_waitcnt vmcnt(4)
L_dp_23:
    buffer_load_dwordx4 v[72:75], v1, s[8:11], s36 offen offset:256 nt
    v_lshlrev_b32 v7, 1, v0
    s_add_u32 s60, s58, 2
    v_mov_b32 v4, s60
    buffer_load_ushort v7, v7, s[16:19], s56 offen sc1
    s_mov_b64 exec, 1
    buffer_store_short v4, off, s[16:19], s57
    s_mov_b64 exec, -1
    s_waitcnt vmcnt(9)
    s_cbranch_vccnz L_dp_24
    s_waitcnt vmcnt(7)
    s_cmp_ge_u32 s62, s63
    s_cbranch_scc1 L_dp_24
    s_waitcnt vmcnt(6)
L_dp_24:
    buffer_load_dwordx4 v[76:79], v1, s[8:11], s36 offen offset:384 nt
    s_waitcnt vmcnt(9)
    s_cbranch_vccnz L_dp_25
    s_waitcnt vmcnt(7)
    s_cmp_ge_u32 s62, s63
    s_cbranch_scc1 L_dp_25
    s_waitcnt vmcnt(6)
L_dp_25:
    s_xor_b32 s36, s36, 16384
    buffer_load_dwordx4 v[80:83], v1, s[8:11], s36 offen offset:0 nt
    s_waitcnt vmcnt(9)
    s_cbranch_vccnz L_dp_26
    s_waitcnt vmcnt(7)
    s_cmp_ge_u32 s62, s63
    s_cbranch_scc1 L_dp_26
    s_waitcnt vmcnt(6)
L_dp_26:
    buffer_load_dwordx4 v[84:87], v1, s[8:11], s36 offen offset:128 nt
    s_waitcnt vmcnt(9)
    s_cbranch_vccnz L_dp_27
    s_waitcnt vmcnt(7)
    s_cmp_ge_u32 s62, s63
    s_cbranch_scc1 L_dp_27
    s_waitcnt vmcnt(6)
L_dp_27:
    buffer_load_dwordx4 v[88:91], v1, s[8:11], s36 offen offset:256 nt
    s_load_dword s24, s[12:13], 0
    v_mov_b32 v4, 0
    v_mov_b32 v5, 1
    s_mov_b64 exec, 1
    ds_add_u32 v4, v5 offset:40
    s_mov_b64 exec, -1
    s_waitcnt vmcnt(9)
    s_cbranch_vccnz L_dp_28
    s_waitcnt vmcnt(7)
    s_cmp_ge_u32 s62, s63
    s_cbranch_scc1 L_dp_28
    s_waitcnt vmcnt(6)
L_dp_28:
    buffer_load_dwordx4 v[92:95], v1, s[8:11], s36 offen offset:384 nt
    s_waitcnt vmcnt(9)
    s_cbranch_vccnz L_dp_29
    s_waitcnt vmcnt(7)
    s_cmp_ge_u32 s62, s63
    s_cbranch_scc1 L_dp_29
    s_waitcnt vmcnt(4)
L_dp_29:
    s_xor_b32 s36, s36, 933888
    buffer_load_dwordx4 v[96:99], v1, s[8:11], s36 offen offset:0 nt
    s_waitcnt vmcnt(9)
    s_cbranch_vccnz L_dp_30
    s_waitcnt vmcnt(5)
    s_cmp_ge_u32 s62, s63
    s_cbranch_scc1 L_dp_30
    s_waitcnt vmcnt(4)
L_dp_30:
    buffer_load_dwordx4 v[100:103], v1, s[8:11], s36 offen offset:128 nt
    s_waitcnt vmcnt(9)
    s_cbranch_vccnz L_dp_31
    s_waitcnt vmcnt(5)
    s_cmp_ge_u32 s62, s63
    s_cbranch_scc1 L_dp_31
    s_waitcnt vmcnt(4)
L_dp_31:
    buffer_load_dwordx4 v[104:107], v1, s[8:11], s36 offen offset:256 nt
    s_waitcnt vmcnt(7)
    s_add_u32 s60, s58, 2
    v_subrev_u32 v7, s60, v7
    v_cmp_gt_u32 vcc, 14, v7
    s_bcnt1_i32_b64 s62, vcc
    s_cmp_ge_u32 s62, s59
    s_cselect_b64 vcc, -1, 0
    s_cbranch_vccnz L_dp_32
    s_waitcnt vmcnt(5)
    s_cmp_ge_u32 s62, s63
    s_cbranch_scc1 L_dp_32
    s_waitcnt vmcnt(4)
L_dp_32:
    buffer_load_dwordx4 v[108:111], v1, s[8:11], s36 offen offset:384 nt
    s_waitcnt vmcnt(7)
    s_cbranch_vccnz L_dp_33
    s_waitcnt vmcnt(5)
    s_cmp_ge_u32 s62, s63
    s_cbranch_scc1 L_dp_33
    s_waitcnt vmcnt(4)
L_dp_33:
    s_xor_b32 s36, s36, 16384
    buffer_load_dwordx4 v[112:115], v1, s[8:11], s36 offen offset:0 nt
    v_lshlrev_b32 v7, 1, v0
    s_add_u32 s60, s58, 3
    v_mov_b32 v4, s60
    buffer_load_ushort v7, v7, s[16:19], s56 offen sc1
    s_mov_b64 exec, 1
    buffer_store_short v4, off, s[16:19], s57
    s_mov_b64 exec, -1
    s_waitcnt vmcnt(9)
    s_cbranch_vccnz L_dp_34
    s_waitcnt vmcnt(7)
    s_cmp_ge_u32 s62, s63
    s_cbranch_scc1 L_dp_34
    s_waitcnt vmcnt(6)
L_dp_34:
    buffer_load_dwordx4 v[116:119], v1, s[8:11], s36 offen offset:128 nt
    s_waitcnt vmcnt(9)
    s_cbranch_vccnz L_dp_35
    s_waitcnt vmcnt(7)
    s_cmp_ge_u32 s62, s63
    s_cbranch_scc1 L_dp_35
    s_waitcnt vmcnt(6)
L_dp_35:
    buffer_load_dwordx4 v[120:123], v1, s[8:11], s36 offen offset:256 nt
    s_waitcnt vmcnt(9)
    s_cbranch_vccnz L_dp_36
    s_waitcnt vmcnt(7)
    s_cmp_ge_u32 s62, s63
    s_cbranch_scc1 L_dp_36
    s_waitcnt vmcnt(6)
L_dp_36:
    buffer_load_dwordx4 v[124:127], v1, s[8:11], s36 offen offset:384 nt
    s_waitcnt vmcnt(9)
    s_cbranch_vccnz L_dp_37
    s_waitcnt vmcnt(7)
    s_cmp_ge_u32 s62, s63
    s_cbranch_scc1 L_dp_37
    s_waitcnt vmcnt(6)
L_dp_37:
    s_xor_b32 s36, s36, 147456
    buffer_load_dwordx4 v[128:131], v1, s[8:11], s36 offen offset:0 nt
    s_waitcnt vmcnt(9)
    s_cbranch_vccnz L_dp_38
    s_waitcnt vmcnt(7)
    s_cmp_ge_u32 s62, s63
    s_cbranch_scc1 L_dp_38
    s_waitcnt vmcnt(6)
L_dp_38:
    buffer_load_dwordx4 v[132:135], v1, s[8:11], s36 offen offset:128 nt
    s_waitcnt vmcnt(9)
    s_cbranch_vccnz L_dp_39
    s_waitcnt vmcnt(7)
    s_cmp_ge_u32 s62, s63
    s_cbranch_scc1 L_dp_39
    s_waitcnt vmcnt(4)
L_dp_39:
    buffer_load_dwordx4 v[136:139], v1, s[8:11], s36 offen offset:256 nt
    s_waitcnt vmcnt(9)
    s_cbranch_vccnz L_dp_40
    s_waitcnt vmcnt(5)
    s_cmp_ge_u32 s62, s63
    s_cbranch_scc1 L_dp_40
    s_waitcnt vmcnt(4)
L_dp_40:
    buffer_load_dwordx4 v[140:143], v1, s[8:11], s36 offen offset:384 nt
    s_waitcnt vmcnt(9)
    s_cbranch_vccnz L_dp_41
    s_waitcnt vmcnt(5)
    s_cmp_ge_u32 s62, s63
    s_cbranch_scc1 L_dp_41
    s_waitcnt vmcnt(4)
L_dp_41:
    s_xor_b32 s36, s36, 16384
    buffer_load_dwordx4 v[144:147], v1, s[8:11], s36 offen offset:0 nt
    s_waitcnt vmcnt(7)
    s_add_u32 s60, s58, 3
    v_subrev_u32 v7, s60, v7
    v_cmp_gt_u32 vcc, 13, v7
    s_bcnt1_i32_b64 s62, vcc
    s_cmp_ge_u32 s62, s59
    s_cselect_b64 vcc, -1, 0
    s_cbranch_vccnz L_dp_42
    s_waitcnt vmcnt(5)
    s_cmp_ge_u32 s62, s63
    s_cbranch_scc1 L_dp_42
    s_waitcnt vmcnt(4)
L_dp_42:
    buffer_load_dwordx4 v[148:151], v1, s[8:11], s36 offen offset:128 nt
    s_waitcnt vmcnt(7)
    s_cbranch_vccnz L_dp_43
    s_waitcnt vmcnt(5)
    s_cmp_ge_u32 s62, s63
    s_cbranch_scc1 L_dp_43
    s_waitcnt vmcnt(4)
L_dp_43:
    buffer_load_dwordx4 v[152:155], v1, s[8:11], s36 offen offset:256 nt
    v_lshlrev_b32 v7, 1, v0
    s_add_u32 s60, s58, 4
    v_mov_b32 v4, s60
    buffer_load_ushort v7, v7, s[16:19], s56 offen sc1
    s_mov_b64 exec, 1
    buffer_store_short v4, off, s[16:19], s57
    s_mov_b64 exec, -1
    s_waitcnt vmcnt(9)
    s_cbranch_vccnz L_dp_44
    s_waitcnt vmcnt(7)
    s_cmp_ge_u32 s62, s63
    s_cbranch_scc1 L_dp_44
    s_waitcnt vmcnt(6)
L_dp_44:
    buffer_load_dwordx4 v[156:159], v1, s[8:11], s36 offen offset:384 nt
    s_waitcnt vmcnt(9)
    s_cbranch_vccnz L_dp_45
    s_waitcnt vmcnt(7)
    s_cmp_ge_u32 s62, s63
    s_cbranch_scc1 L_dp_45
    s_waitcnt vmcnt(6)
L_dp_45:
    s_xor_b32 s36, s36, 409600
    buffer_load_dwordx4 v[160:163], v1, s[8:11], s36 offen offset:0 nt
    s_waitcnt vmcnt(9)
    s_cbranch_vccnz L_dp_46
    s_waitcnt vmcnt(7)
    s_cmp_ge_u32 s62, s63
    s_cbranch_scc1 L_dp_46
    s_waitcnt vmcnt(6)
L_dp_46:
    buffer_load_dwordx4 v[164:167], v1, s[8:11], s36 offen offset:128 nt
    s_waitcnt vmcnt(9)
    s_cbranch_vccnz L_dp_47
    s_waitcnt vmcnt(7)
    s_cmp_ge_u32 s62, s63
    s_cbranch_scc1 L_dp_47
    s_waitcnt vmcnt(6)
L_dp_47:
    buffer_load_dwordx4 v[168:171], v1, s[8:11], s36 offen offset:256 nt
    s_waitcnt vmcnt(9)
    s_cbranch_vccnz L_dp_48
    s_waitcnt vmcnt(7)
    s_cmp_ge_u32 s62, s63
    s_cbranch_scc1 L_dp_48
    s_waitcnt vmcnt(6)
L_dp_48:
    buffer_load_dwordx4 v[172:175], v1, s[8:11], s36 offen offset:384 nt
    s_waitcnt vmcnt(9)
    s_cbranch_vccnz L_dp_49
    s_waitcnt vmcnt(7)
    s_cmp_ge_u32 s62, s63
    s_cbranch_scc1 L_dp_49
    s_waitcnt vmcnt(4)
L_dp_49:
    s_xor_b32 s36, s36, 16384
    buffer_load_dwordx4 v[176:179], v1, s[8:11], s36 offen offset:0 nt
    s_waitcnt vmcnt(9)
    s_cbranch_vccnz L_dp_50
    s_waitcnt vmcnt(5)
    s_cmp_ge_u32 s62, s63
    s_cbranch_scc1 L_dp_50
    s_waitcnt vmcnt(4)
L_dp_50:
    buffer_load_dwordx4 v[180:183], v1, s[8:11], s36 offen offset:128 nt
    s_waitcnt vmcnt(9)
    s_cbranch_vccnz L_dp_51
    s_waitcnt vmcnt(5)
    s_cmp_ge_u32 s62, s63
    s_cbranch_scc1 L_dp_51
    s_waitcnt vmcnt(4)
L_dp_51:
    buffer_load_dwordx4 v[184:187], v1, s[8:11], s36 offen offset:256 nt
    s_waitcnt vmcnt(7)
    s_add_u32 s60, s58, 4
    v_subrev_u32 v7, s60, v7
    v_cmp_gt_u32 vcc, 12, v7
    s_bcnt1_i32_b64 s62, vcc
    s_cmp_ge_u32 s62, s59
    s_cselect_b64 vcc, -1, 0
    s_cbranch_vccnz L_dp_52
    s_waitcnt vmcnt(5)
    s_cmp_ge_u32 s62, s63
    s_cbranch_scc1 L_dp_52
    s_waitcnt vmcnt(4)
L_dp_52:
    buffer_load_dwordx4 v[188:191], v1, s[8:11], s36 offen offset:384 nt
    s_waitcnt vmcnt(7)
    s_cbranch_vccnz L_dp_53
    s_waitcnt vmcnt(5)
    s_cmp_ge_u32 s62, s63
    s_cbranch_scc1 L_dp_53
    s_waitcnt vmcnt(4)
L_dp_53:
    s_xor_b32 s36, s36, 147456
    buffer_load_dwordx4 v[192:195], v1, s[8:11], s36 offen offset:0 nt
    v_lshlrev_b32 v7, 1, v0
    s_add_u32 s60, s58, 5
    v_mov_b32 v4, s60
    buffer_load_ushort v7, v7, s[16:19], s56 offen sc1
    s_mov_b64 exec, 1
    buffer_store_short v4, off, s[16:19], s57
    s_mov_b64 exec, -1
    s_waitcnt vmcnt(9)
    s_cbranch_vccnz L_dp_54
    s_waitcnt vmcnt(7)
    s_cmp_ge_u32 s62, s63
    s_cbranch_scc1 L_dp_54
    s_waitcnt vmcnt(6)
L_dp_54:
    buffer_load_dwordx4 v[196:199], v1, s[8:11], s36 offen offset:128 nt
    s_waitcnt vmcnt(9)
    s_cbranch_vccnz L_dp_55
    s_waitcnt vmcnt(7)
    s_cmp_ge_u32 s62, s63
    s_cbranch_scc1 L_dp_55
    s_waitcnt vmcnt(6)
L_dp_55:
    buffer_load_dwordx4 v[200:203], v1, s[8:11], s36 offen offset:256 nt
    s_waitcnt vmcnt(9)
    s_cbranch_vccnz L_dp_56
    s_waitcnt vmcnt(7)
    s_cmp_ge_u32 s62, s63
    s_cbranch_scc1 L_dp_56
    s_waitcnt vmcnt(6)
L_dp_56:
    buffer_load_dwordx4 v[204:207], v1, s[8:11], s36 offen offset:384 nt
    s_waitcnt vmcnt(9)
    s_cbranch_vccnz L_dp_57
    s_waitcnt vmcnt(7)
    s_cmp_ge_u32 s62, s63
    s_cbranch_scc1 L_dp_57
    s_waitcnt vmcnt(6)
L_dp_57:
    s_xor_b32 s36, s36, 16384
    buffer_load_dwordx4 v[208:211], v1, s[8:11], s36 offen offset:0 nt
    v_mov_b32 v4, 0
    v_mov_b32 v5, 1
    s_mov_b64 exec, 1
    ds_add_u32 v4, v5 offset:16
    s_mov_b64 exec, -1
    s_waitcnt vmcnt(9)
    s_cbranch_vccnz L_dp_58
    s_waitcnt vmcnt(7)
    s_cmp_ge_u32 s62, s63
    s_cbranch_scc1 L_dp_58
    s_waitcnt vmcnt(6)
L_dp_58:
    buffer_load_dwordx4 v[212:215], v1, s[8:11], s36 offen offset:128 nt
    s_waitcnt vmcnt(9)
    s_cbranch_vccnz L_dp_59
    s_waitcnt vmcnt(7)
    s_cmp_ge_u32 s62, s63
    s_cbranch_scc1 L_dp_59
    s_waitcnt vmcnt(4)
L_dp_59:
    buffer_load_dwordx4 v[216:219], v1, s[8:11], s36 offen offset:256 nt
    s_waitcnt vmcnt(9)
    s_cbranch_vccnz L_dp_60
    s_waitcnt vmcnt(5)
    s_cmp_ge_u32 s62, s63
    s_cbranch_scc1 L_dp_60
    s_waitcnt vmcnt(4)
L_dp_60:
    buffer_load_dwordx4 v[220:223], v1, s[8:11], s36 offen offset:384 nt
    s_waitcnt vmcnt(9)
    s_cbranch_vccnz L_dp_61
    s_waitcnt vmcnt(5)
    s_cmp_ge_u32 s62, s63
    s_cbranch_scc1 L_dp_61
    s_waitcnt vmcnt(4)
L_dp_61:
    s_add_u32 s30, s37, 0
    buffer_load_dwordx4 v[224:227], v2, s[12:15], s30 offen nt
    s_waitcnt vmcnt(7)
    s_add_u32 s60, s58, 5
    v_subrev_u32 v7, s60, v7
    v_cmp_gt_u32 vcc, 11, v7
    s_bcnt1_i32_b64 s62, vcc
    s_cmp_ge_u32 s62, s59
    s_cselect_b64 vcc, -1, 0
    s_cbranch_vccnz L_dp_62
    s_waitcnt vmcnt(5)
    s_cmp_ge_u32 s62, s63
    s_cbranch_scc1 L_dp_62
    s_waitcnt vmcnt(4)
L_dp_62:
    s_add_u32 s30, s37, 8192
    buffer_load_dwordx4 v[228:231], v2, s[12:15], s30 offen nt
    s_waitcnt vmcnt(7)
    s_cbranch_vccnz L_dp_63
    s_waitcnt vmcnt(5)
    s_cmp_ge_u32 s62, s63
    s_cbranch_scc1 L_dp_63
    s_waitcnt vmcnt(4)
L_dp_63:
    s_add_u32 s30, s37, 4096
    buffer_load_dwordx4 v[232:235], v2, s[12:15], s30 offen nt
    s_waitcnt vmcnt(7)
    s_cbranch_vccnz L_dp_64
    s_waitcnt vmcnt(5)
    s_cmp_ge_u32 s62, s63
    s_cbranch_scc1 L_dp_64
    s_waitcnt vmcnt(4)
L_dp_64:
    s_add_u32 s30, s37, 12288
    buffer_load_dwordx4 v[236:239], v2, s[12:15], s30 offen nt
    s_waitcnt vmcnt(7)
    s_cbranch_vccnz L_dp_65
    s_waitcnt vmcnt(5)
    s_cmp_ge_u32 s62, s63
    s_cbranch_scc1 L_dp_65
    s_waitcnt vmcnt(4)
L_dp_65:
    s_add_u32 s30, s37, 16384
    buffer_load_dwordx4 v[240:243], v2, s[12:15], s30 offen nt
    s_waitcnt vmcnt(7)
    s_cbranch_vccnz L_dp_66
    s_waitcnt vmcnt(5)
    s_cmp_ge_u32 s62, s63
    s_cbranch_scc1 L_dp_66
    s_waitcnt vmcnt(4)
L_dp_66:
    s_add_u32 s30, s37, 24576
    buffer_load_dwordx4 v[244:247], v2, s[12:15], s30 offen nt
    s_waitcnt vmcnt(7)
    s_cbranch_vccnz L_dp_67
    s_waitcnt vmcnt(5)
    s_cmp_ge_u32 s62, s63
    s_cbranch_scc1 L_dp_67
    s_waitcnt vmcnt(4)
L_dp_67:
    s_add_u32 s30, s37, 20480
    buffer_load_dwordx4 v[248:251], v2, s[12:15], s30 offen nt
    s_waitcnt vmcnt(7)
    s_cbranch_vccnz L_dp_68
    s_waitcnt vmcnt(5)
    s_cmp_ge_u32 s62, s63
    s_cbranch_scc1 L_dp_68
    s_waitcnt vmcnt(4)
L_dp_68:
    s_add_u32 s30, s37, 28672
    buffer_load_dwordx4 v[252:255], v2, s[12:15], s30 offen nt
    s_waitcnt vmcnt(7)
    s_cbranch_vccnz L_dp_69
    s_waitcnt vmcnt(5)
    s_cmp_ge_u32 s62, s63
    s_cbranch_scc1 L_dp_69
    s_waitcnt vmcnt(4)
L_dp_69:
L_spin_70:
    v_mov_b32 v4, 0
    ds_read_b32 v4, v4 offset:0
    s_waitcnt lgkmcnt(0)
    v_readfirstlane_b32 s31, v4
    s_cmp_ge_u32 s31, 1
    s_cbranch_scc1 L_got_71
    s_add_u32 s33, s33, 1
    s_cmp_lt_u32 s33, 400000
    s_cbranch_scc1 L_spin_70
    s_branch L_exit
L_got_71:
    v_lshrrev_b32 v4, 1, v0
    v_and_b32 v4, 1, v4
    v_and_b32 v5, 1, v0
    v_lshrrev_b32 v6, 4, v0
    v_lshlrev_b32 v6, 4, v6
    v_lshl_or_b32 v6, v5, 6, v6
    v_lshl_or_b32 v3, v4, 9, v6
    ds_read_b128 v[8:11], v3 offset:1024
    ds_read_b128 v[12:15], v3 offset:1152
    ds_read_b128 v[16:19], v3 offset:1280
    ds_read_b128 v[20:23], v3 offset:1408
    v_lshl_add_u32 v3, v0, 4, s27
    s_waitcnt lgkmcnt(0)
    v_mfma_f32_16x16x32_bf16 v[24:27], v[8:11], v[64:67], 0
    v_mfma_f32_16x16x32_bf16 v[24:27], v[12:15], v[68:71], v[24:27]
    v_mfma_f32_16x16x32_bf16 v[24:27], v[16:19], v[72:75], v[24:27]
    v_mfma_f32_16x16x32_bf16 v[24:27], v[20:23], v[76:79], v[24:27]
    s_nop 7
    v_add_f32_dpp v6, v25, v24 row_ror:8 row_mask:0x2 bank_mask:0x3
    v_add_f32_dpp v6, v26, v27 row_ror:8 row_mask:0x2 bank_mask:0xc
    s_add_u32 s30, s37, 131072
    buffer_load_dwordx4 v[64:67], v2, s[12:15], s30 offen nt
    v_mfma_f32_16x16x32_bf16 v[28:31], v[8:11], v[32:35], 0
    v_mfma_f32_16x16x32_bf16 v[28:31], v[12:15], v[36:39], v[28:31]
    v_mfma_f32_16x16x32_bf16 v[28:31], v[16:19], v[40:43], v[28:31]
    v_mfma_f32_16x16x32_bf16 v[28:31], v[20:23], v[44:47], v[28:31]
    v_mfma_f32_16x16x32_bf16 v[24:27], v[8:11], v[48:51], 0
    v_mfma_f32_16x16x32_bf16 v[24:27], v[12:15], v[52:55], v[24:27]
    v_mfma_f32_16x16x32_bf16 v[24:27], v[16:19], v[56:59], v[24:27]
    v_mfma_f32_16x16x32_bf16 v[24:27], v[20:23], v[60:63], v[24:27]
    s_nop 3
    v_add_f32_dpp v4, v29, v28 row_ror:8 row_mask:0x1 bank_mask:0x3
    v_add_f32_dpp v4, v30, v31 row_ror:8 row_mask:0x1 bank_mask:0xc
    ds_read_b128 v[32:35], v3 offset:0
    ds_read_b128 v[36:39], v3 offset:1024
    ds_read_b128 v[40:43], v3 offset:2048
    ds_read_b128 v[44:47], v3 offset:3072
    ds_read_b128 v[48:51], v3 offset:4096
    ds_read_b128 v[52:55], v3 offset:5120
    ds_read_b128 v[56:59], v3 offset:6144
    ds_read_b128 v[60:63], v3 offset:7168
    v_mfma_f32_16x16x32_bf16 v[28:31], v[8:11], v[80:83], 0
    v_mfma_f32_16x16x32_bf16 v[28:31], v[12:15], v[84:87], v[28:31]
    v_mfma_f32_16x16x32_bf16 v[28:31], v[16:19], v[88:91], v[28:31]
    v_mfma_f32_16x16x32_bf16 v[28:31], v[20:23], v[92:95], v[28:31]
    v_add_f32_dpp v5, v25, v24 row_ror:8 row_mask:0x2 bank_mask:0x3
    v_add_f32_dpp v5, v26, v27 row_ror:8 row_mask:0x2 bank_mask:0xc
    s_waitcnt lgkmcnt(0)
    v_mfma_f32_16x16x32_bf16 v[24:27], v[8:11], v[32:35], 0
    v_mfma_f32_16x16x32_bf16 v[24:27], v[12:15], v[36:39], v[24:27]
    v_mfma_f32_16x16x32_bf16 v[24:27], v[16:19], v[40:43], v[24:27]
    v_mfma_f32_16x16x32_bf16 v[24:27], v[20:23], v[44:47], v[24:27]
    s_nop 0
    v_add_f32_dpp v7, v29, v28 row_ror:8 row_mask:0x2 bank_mask:0x3
    v_add_f32_dpp v7, v30, v31 row_ror:8 row_mask:0x2 bank_mask:0xc
    s_nop 4
    v_add_f32_dpp v5, v25, v24 row_ror:8 row_mask:0x1 bank_mask:0x3
    v_add_f32_dpp v5, v26, v27 row_ror:8 row_mask:0x1 bank_mask:0xc
    s_waitcnt vmcnt(7)
    s_cbranch_vccnz L_dp_72
    s_waitcnt vmcnt(5)
    s_cmp_ge_u32 s62, s63
    s_cbranch_scc1 L_dp_72
    s_waitcnt vmcnt(4)
L_dp_72:
    s_add_u32 s30, s37, 139264
    buffer_load_dwordx4 v[68:71], v2, s[12:15], s30 offen nt
    v_mfma_f32_16x16x32_bf16 v[28:31], v[8:11], v[48:51], 0
    v_mfma_f32_16x16x32_bf16 v[28:31], v[12:15], v[52:55], v[28:31]
    v_mfma_f32_16x16x32_bf16 v[28:31], v[16:19], v[56:59], v[28:31]
    v_mfma_f32_16x16x32_bf16 v[28:31], v[20:23], v[60:63], v[28:31]
    ds_read_b128 v[32:35], v3 offset:8192
    ds_read_b128 v[36:39], v3 offset:9216
    ds_read_b128 v[40:43], v3 offset:10240
    ds_read_b128 v[44:47], v3 offset:11264
    ds_read_b128 v[48:51], v3 offset:12288
    ds_read_b128 v[52:55], v3 offset:13312
    ds_read_b128 v[56:59], v3 offset:14336
    ds_read_b128 v[60:63], v3 offset:15360
    v_mfma_f32_16x16x32_bf16 v[24:27], v[8:11], v[96:99], 0
    v_mfma_f32_16x16x32_bf16 v[24:27], v[12:15], v[100:103], v[24:27]
    v_mfma_f32_16x16x32_bf16 v[24:27], v[16:19], v[104:107], v[24:27]
    v_mfma_f32_16x16x32_bf16 v[24:27], v[20:23], v[108:111], v[24:27]
    v_add_f32_dpp v6, v29, v28 row_ror:8 row_mask:0x1 bank_mask:0x3
    v_add_f32_dpp v6, v30, v31 row_ror:8 row_mask:0x1 bank_mask:0xc
    s_waitcnt lgkmcnt(0)
    v_mfma_f32_16x16x32_bf16 v[28:31], v[8:11], v[32:35], 0
    v_mfma_f32_16x16x32_bf16 v[28:31], v[12:15], v[36:39], v[28:31]
    v_mfma_f32_16x16x32_bf16 v[28:31], v[16:19], v[40:43], v[28:31]
    v_mfma_f32_16x16x32_bf16 v[28:31], v[20:23], v[44:47], v[28:31]
    s_nop 0
    v_add_f32_dpp v4, v25, v24 row_ror:8 row_mask:0x4 bank_mask:0x3
    v_add_f32_dpp v4, v26, v27 row_ror:8 row_mask:0x4 bank_mask:0xc
    v_mfma_f32_16x16x32_bf16 v[24:27], v[8:11], v[48:51], 0
    v_mfma_f32_16x16x32_bf16 v[24:27], v[12:15], v[52:55], v[24:27]
    v_mfma_f32_16x16x32_bf16 v[24:27], v[16:19], v[56:59], v[24:27]
    v_mfma_f32_16x16x32_bf16 v[24:27], v[20:23], v[60:63], v[24:27]
    s_nop 0
    v_add_f32_dpp v7, v29, v28 row_ror:8 row_mask:0x1 bank_mask:0x3
    v_add_f32_dpp v7, v30, v31 row_ror:8 row_mask:0x1 bank_mask:0xc
    s_nop 4
    v_add_f32_dpp v4, v25, v24 row_ror:8 row_mask:0x2 bank_mask:0x3
    v_add_f32_dpp v4, v26, v27 row_ror:8 row_mask:0x2 bank_mask:0xc
    s_waitcnt vmcnt(7)
    s_cbranch_vccnz L_dp_73
    s_waitcnt vmcnt(5)
    s_cmp_ge_u32 s62, s63
    s_cbranch_scc1 L_dp_73
    s_waitcnt vmcnt(4)
L_dp_73:
    s_add_u32 s30, s37, 135168
    buffer_load_dwordx4 v[72:75], v2, s[12:15], s30 offen nt
    v_mfma_f32_16x16x32_bf16 v[28:31], v[8:11], v[112:115], 0
    v_mfma_f32_16x16x32_bf16 v[28:31], v[12:15], v[116:119], v[28:31]
    v_mfma_f32_16x16x32_bf16 v[28:31], v[16:19], v[120:123], v[28:31]
    v_mfma_f32_16x16x32_bf16 v[28:31], v[20:23], v[124:127], v[28:31]
    v_mfma_f32_16x16x32_bf16 v[24:27], v[8:11], v[128:131], 0
    v_mfma_f32_16x16x32_bf16 v[24:27], v[12:15], v[132:135], v[24:27]
    v_mfma_f32_16x16x32_bf16 v[24:27], v[16:19], v[136:139], v[24:27]
    v_mfma_f32_16x16x32_bf16 v[24:27], v[20:23], v[140:143], v[24:27]
    s_nop 3
    v_add_f32_dpp v5, v29, v28 row_ror:8 row_mask:0x4 bank_mask:0x3
    v_add_f32_dpp v5, v30, v31 row_ror:8 row_mask:0x4 bank_mask:0xc
    v_mfma_f32_16x16x32_bf16 v[28:31], v[8:11], v[144:147], 0
    v_mfma_f32_16x16x32_bf16 v[28:31], v[12:15], v[148:151], v[28:31]
    v_mfma_f32_16x16x32_bf16 v[28:31], v[16:19], v[152:155], v[28:31]
    v_mfma_f32_16x16x32_bf16 v[28:31], v[20:23], v[156:159], v[28:31]
    v_add_f32_dpp v6, v25, v24 row_ror:8 row_mask:0x4 bank_mask:0x3
    v_add_f32_dpp v6, v26, v27 row_ror:8 row_mask:0x4 bank_mask:0xc
    v_mfma_f32_16x16x32_bf16 v[24:27], v[8:11], v[160:163], 0
    v_mfma_f32_16x16x32_bf16 v[24:27], v[12:15], v[164:167], v[24:27]
    v_mfma_f32_16x16x32_bf16 v[24:27], v[16:19], v[168:171], v[24:27]
    v_mfma_f32_16x16x32_bf16 v[24:27], v[20:23], v[172:175], v[24:27]
    s_nop 1
    v_add_f32_dpp v7, v29, v28 row_ror:8 row_mask:0x4 bank_mask:0x3
    v_add_f32_dpp v7, v30, v31 row_ror:8 row_mask:0x4 bank_mask:0xc
    s_nop 3
    v_add_f32_dpp v4, v25, v24 row_ror:8 row_mask:0x8 bank_mask:0x3
    v_add_f32_dpp v4, v26, v27 row_ror:8 row_mask:0x8 bank_mask:0xc
    s_waitcnt vmcnt(7)
    s_cbranch_vccnz L_dp_74
    s_waitcnt vmcnt(5)
    s_cmp_ge_u32 s62, s63
    s_cbranch_scc1 L_dp_74
    s_waitcnt vmcnt(4)
L_dp_74:
    s_add_u32 s30, s37, 143360
    buffer_load_dwordx4 v[76:79], v2, s[12:15], s30 offen nt
    v_mfma_f32_16x16x32_bf16 v[28:31], v[8:11], v[176:179], 0
    v_mfma_f32_16x16x32_bf16 v[28:31], v[12:15], v[180:183], v[28:31]
    v_mfma_f32_16x16x32_bf16 v[28:31], v[16:19], v[184:187], v[28:31]
    v_mfma_f32_16x16x32_bf16 v[28:31], v[20:23], v[188:191], v[28:31]
    v_mfma_f32_16x16x32_bf16 v[24:27], v[8:11], v[192:195], 0
    v_mfma_f32_16x16x32_bf16 v[24:27], v[12:15], v[196:199], v[24:27]
    v_mfma_f32_16x16x32_bf16 v[24:27], v[16:19], v[200:203], v[24:27]
    v_mfma_f32_16x16x32_bf16 v[24:27], v[20:23], v[204:207], v[24:27]
    s_nop 3
    v_add_f32_dpp v5, v29, v28 row_ror:8 row_mask:0x8 bank_mask:0x3
    v_add_f32_dpp v5, v30, v31 row_ror:8 row_mask:0x8 bank_mask:0xc
    v_mfma_f32_16x16x32_bf16 v[28:31], v[8:11], v[208:211], 0
    v_mfma_f32_16x16x32_bf16 v[28:31], v[12:15], v[212:215], v[28:31]
    v_mfma_f32_16x16x32_bf16 v[28:31], v[16:19], v[216:219], v[28:31]
    v_mfma_f32_16x16x32_bf16 v[28:31], v[20:23], v[220:223], v[28:31]
    v_add_f32_dpp v6, v25, v24 row_ror:8 row_mask:0x8 bank_mask:0x3
    v_add_f32_dpp v6, v26, v27 row_ror:8 row_mask:0x8 bank_mask:0xc
    s_nop 5
    v_add_f32_dpp v7, v29, v28 row_ror:8 row_mask:0x8 bank_mask:0x3
    v_add_f32_dpp v7, v30, v31 row_ror:8 row_mask:0x8 bank_mask:0xc
    s_lshl_b32 s31, s3, 10
    v_lshl_add_u32 v3, v0, 4, s31
    ds_write_b128 v3, v[4:7] offset:4096
    s_waitcnt lgkmcnt(0)
    v_mov_b32 v4, 0
    v_mov_b32 v5, 1
    s_mov_b64 exec, 1
    ds_add_u32 v4, v5 offset:4
    s_mov_b64 exec, -1
    s_waitcnt vmcnt(7)
    s_cbranch_vccnz L_dp_75
    s_waitcnt vmcnt(5)
    s_cmp_ge_u32 s62, s63
    s_cbranch_scc1 L_dp_75
    s_waitcnt vmcnt(4)
L_dp_75:
    s_add_u32 s30, s37, 147456
    buffer_load_dwordx4 v[80:83], v2, s[12:15], s30 offen nt
    s_waitcnt vmcnt(7)
    s_cbranch_vccnz L_dp_76
    s_waitcnt vmcnt(5)
    s_cmp_ge_u32 s62, s63
    s_cbranch_scc1 L_dp_76
    s_waitcnt vmcnt(4)
L_dp_76:
    s_add_u32 s30, s37, 155648
    buffer_load_dwordx4 v[84:87], v2, s[12:15], s30 offen nt
    v_lshlrev_b32 v7, 1, v0
    s_add_u32 s60, s58, 6
    v_mov_b32 v4, s60
    buffer_load_ushort v7, v7, s[16:19], s56 offen sc1
    s_mov_b64 exec, 1
    buffer_store_short v4, off, s[16:19], s57
    s_mov_b64 exec, -1
    s_waitcnt vmcnt(9)
    s_cbranch_vccnz L_dp_77
    s_waitcnt vmcnt(7)
    s_cmp_ge_u32 s62, s63
    s_cbranch_scc1 L_dp_77
    s_waitcnt vmcnt(6)
L_dp_77:
    s_add_u32 s30, s37, 151552
    buffer_load_dwordx4 v[88:91], v2, s[12:15], s30 offen nt
    s_waitcnt vmcnt(9)
    s_cbranch_vccnz L_dp_78
    s_waitcnt vmcnt(7)
    s_cmp_ge_u32 s62, s63
    s_cbranch_scc1 L_dp_78
    s_waitcnt vmcnt(6)
L_dp_78:
    s_add_u32 s30, s37, 159744
    buffer_load_dwordx4 v[92:95], v2, s[12:15], s30 offen nt
    s_waitcnt vmcnt(9)
    s_cbranch_vccnz L_dp_79
    s_waitcnt vmcnt(7)
    s_cmp_ge_u32 s62, s63
    s_cbranch_scc1 L_dp_79
    s_waitcnt vmcnt(6)
L_dp_79:
    s_add_u32 s30, s37, 262144
    buffer_load_dwordx4 v[96:99], v2, s[12:15], s30 offen nt
    s_waitcnt vmcnt(9)
    s_cbranch_vccnz L_dp_80
    s_waitcnt vmcnt(7)
    s_cmp_ge_u32 s62, s63
    s_cbranch_scc1 L_dp_80
    s_waitcnt vmcnt(6)
L_dp_80:
    s_add_u32 s30, s37, 270336
    buffer_load_dwordx4 v[100:103], v2, s[12:15], s30 offen nt
    s_waitcnt vmcnt(9)
    s_cbranch_vccnz L_dp_81
    s_waitcnt vmcnt(7)
    s_cmp_ge_u32 s62, s63
    s_cbranch_scc1 L_dp_81
    s_waitcnt vmcnt(6)
L_dp_81:
    s_add_u32 s30, s37, 266240
    buffer_load_dwordx4 v[104:107], v2, s[12:15], s30 offen nt
    s_waitcnt vmcnt(9)
    s_cbranch_vccnz L_dp_82
    s_waitcnt vmcnt(7)
    s_cmp_ge_u32 s62, s63
    s_cbranch_scc1 L_dp_82
    s_waitcnt vmcnt(4)
L_dp_82:
    s_add_u32 s30, s37, 274432
    buffer_load_dwordx4 v[108:111], v2, s[12:15], s30 offen nt
    s_waitcnt vmcnt(9)
    s_cbranch_vccnz L_dp_83
    s_waitcnt vmcnt(5)
    s_cmp_ge_u32 s62, s63
    s_cbranch_scc1 L_dp_83
    s_waitcnt vmcnt(4)
L_dp_83:
    s_add_u32 s30, s37, 278528
    buffer_load_dwordx4 v[112:115], v2, s[12:15], s30 offen nt
    s_mul_i32 s31, s4, 458752
    s_load_dword s24, s[48:49], s31
    s_load_dword s25, s[48:49], s31 offset:458748
    s_load_dword s26, s[52:53], 0
    s_load_dword s27, s[54:55], 0
    s_waitcnt vmcnt(9)
    s_cbranch_vccnz L_dp_84
    s_waitcnt vmcnt(5)
    s_cmp_ge_u32 s62, s63
    s_cbranch_scc1 L_dp_84
    s_waitcnt vmcnt(4)
L_dp_84:
    s_add_u32 s30, s37, 286720
    buffer_load_dwordx4 v[116:119], v2, s[12:15], s30 offen nt
    s_waitcnt vmcnt(7)
    s_add_u32 s60, s58, 6
    v_subrev_u32 v7, s60, v7
    v_cmp_gt_u32 vcc, 10, v7
    s_bcnt1_i32_b64 s62, vcc
    s_cmp_ge_u32 s62, s59
    s_cselect_b64 vcc, -1, 0
    s_cbranch_vccnz L_dp_85
    s_waitcnt vmcnt(5)
    s_cmp_ge_u32 s62, s63
    s_cbranch_scc1 L_dp_85
    s_waitcnt vmcnt(4)
L_dp_85:
    s_add_u32 s30, s37, 282624
    buffer_load_dwordx4 v[120:123], v2, s[12:15], s30 offen nt
    s_waitcnt vmcnt(7)
    s_cbranch_vccnz L_dp_86
    s_waitcnt vmcnt(5)
    s_cmp_ge_u32 s62, s63
    s_cbranch_scc1 L_dp_86
    s_waitcnt vmcnt(4)
L_dp_86:
    s_add_u32 s30, s37, 290816
    buffer_load_dwordx4 v[124:127], v2, s[12:15], s30 offen nt
    v_lshlrev_b32 v7, 1, v0
    s_add_u32 s60, s58, 7
    v_mov_b32 v4, s60
    buffer_load_ushort v7, v7, s[16:19], s56 offen sc1
    s_mov_b64 exec, 1
    buffer_store_short v4, off, s[16:19], s57
    s_mov_b64 exec, -1
    s_waitcnt vmcnt(9)
    s_cbranch_vccnz L_dp_87
    s_waitcnt vmcnt(7)
    s_cmp_ge_u32 s62, s63
    s_cbranch_scc1 L_dp_87
    s_waitcnt vmcnt(6)
L_dp_87:
    s_add_u32 s30, s37, 393216
    buffer_load_dwordx4 v[128:131], v2, s[12:15], s30 offen nt
    s_waitcnt vmcnt(9)
    s_cbranch_vccnz L_dp_88
    s_waitcnt vmcnt(7)
    s_cmp_ge_u32 s62, s63
    s_cbranch_scc1 L_dp_88
    s_waitcnt vmcnt(6)
L_dp_88:
    s_add_u32 s30, s37, 401408
    buffer_load_dwordx4 v[132:135], v2, s[12:15], s30 offen nt
    s_waitcnt vmcnt(9)
    s_cbranch_vccnz L_dp_89
    s_waitcnt vmcnt(7)
    s_cmp_ge_u32 s62, s63
    s_cbranch_scc1 L_dp_89
    s_waitcnt vmcnt(6)
L_dp_89:
    s_add_u32 s30, s37, 397312
    buffer_load_dwordx4 v[136:139], v2, s[12:15], s30 offen nt
    s_waitcnt vmcnt(9)
    s_cbranch_vccnz L_dp_90
    s_waitcnt vmcnt(7)
    s_cmp_ge_u32 s62, s63
    s_cbranch_scc1 L_dp_90
    s_waitcnt vmcnt(6)
L_dp_90:
    s_add_u32 s30, s37, 405504
    buffer_load_dwordx4 v[140:143], v2, s[12:15], s30 offen nt
    s_waitcnt vmcnt(9)
    s_cbranch_vccnz L_dp_91
    s_waitcnt vmcnt(7)
    s_cmp_ge_u32 s62, s63
    s_cbranch_scc1 L_dp_91
    s_waitcnt vmcnt(6)
L_dp_91:
    s_add_u32 s30, s37, 409600
    buffer_load_dwordx4 v[144:147], v2, s[12:15], s30 offen nt
    s_waitcnt vmcnt(9)
    s_cbranch_vccnz L_dp_92
    s_waitcnt vmcnt(7)
    s_cmp_ge_u32 s62, s63
    s_cbranch_scc1 L_dp_92
    s_waitcnt vmcnt(4)
L_dp_92:
    s_add_u32 s30, s37, 417792
    buffer_load_dwordx4 v[148:151], v2, s[12:15], s30 offen nt
    s_waitcnt vmcnt(9)
    s_cbranch_vccnz L_dp_93
    s_waitcnt vmcnt(5)
    s_cmp_ge_u32 s62, s63
    s_cbranch_scc1 L_dp_93
    s_waitcnt vmcnt(4)
L_dp_93:
    s_add_u32 s30, s37, 413696
    buffer_load_dwordx4 v[152:155], v2, s[12:15], s30 offen nt
    s_waitcnt vmcnt(9)
    s_cbranch_vccnz L_dp_94
    s_waitcnt vmcnt(5)
    s_cmp_ge_u32 s62, s63
    s_cbranch_scc1 L_dp_94
    s_waitcnt vmcnt(4)
L_dp_94:
    s_add_u32 s30, s37, 421888
    buffer_load_dwordx4 v[156:159], v2, s[12:15], s30 offen nt
    s_waitcnt vmcnt(7)
    s_add_u32 s60, s58, 7
    v_subrev_u32 v7, s60, v7
    v_cmp_gt_u32 vcc, 9, v7
    s_bcnt1_i32_b64 s62, vcc
    s_cmp_ge_u32 s62, s59
    s_cselect_b64 vcc, -1, 0
    s_cbranch_vccnz L_dp_95
    s_waitcnt vmcnt(5)
    s_cmp_ge_u32 s62, s63
    s_cbranch_scc1 L_dp_95
    s_waitcnt vmcnt(4)
L_dp_95:
    s_add_u32 s30, s37, 524288
    buffer_load_dwordx4 v[160:163], v2, s[12:15], s30 offen nt
    s_waitcnt vmcnt(7)
    s_cbranch_vccnz L_dp_96
    s_waitcnt vmcnt(5)
    s_cmp_ge_u32 s62, s63
    s_cbranch_scc1 L_dp_96
    s_waitcnt vmcnt(4)
L_dp_96:
    s_add_u32 s30, s37, 532480
    buffer_load_dwordx4 v[164:167], v2, s[12:15], s30 offen nt
    v_lshlrev_b32 v7, 1, v0
    s_add_u32 s60, s58, 8
    v_mov_b32 v4, s60
    buffer_load_ushort v7, v7, s[16:19], s56 offen sc1
    s_mov_b64 exec, 1
    buffer_store_short v4, off, s[16:19], s57
    s_mov_b64 exec, -1
    s_waitcnt vmcnt(9)
    s_cbranch_vccnz L_dp_97
    s_waitcnt vmcnt(7)
    s_cmp_ge_u32 s62, s63
    s_cbranch_scc1 L_dp_97
    s_waitcnt vmcnt(6)
L_dp_97:
    s_add_u32 s30, s37, 528384
    buffer_load_dwordx4 v[168:171], v2, s[12:15], s30 offen nt
    s_waitcnt vmcnt(9)
    s_cbranch_vccnz L_dp_98
    s_waitcnt vmcnt(7)
    s_cmp_ge_u32 s62, s63
    s_cbranch_scc1 L_dp_98
    s_waitcnt vmcnt(6)
L_dp_98:
    s_add_u32 s30, s37, 536576
    buffer_load_dwordx4 v[172:175], v2, s[12:15], s30 offen nt
    s_waitcnt vmcnt(9)
    s_cbranch_vccnz L_dp_99
    s_waitcnt vmcnt(7)
    s_cmp_ge_u32 s62, s63
    s_cbranch_scc1 L_dp_99
    s_waitcnt vmcnt(6)
L_dp_99:
    s_add_u32 s30, s37, 540672
    buffer_load_dwordx4 v[176:179], v2, s[12:15], s30 offen nt
    s_waitcnt vmcnt(9)
    s_cbranch_vccnz L_dp_100
    s_waitcnt vmcnt(7)
    s_cmp_ge_u32 s62, s63
    s_cbranch_scc1 L_dp_100
    s_waitcnt vmcnt(6)
L_dp_100:
    s_add_u32 s30, s37, 548864
    buffer_load_dwordx4 v[180:183], v2, s[12:15], s30 offen nt
    s_waitcnt vmcnt(9)
    s_cbranch_vccnz L_dp_101
    s_waitcnt vmcnt(7)
    s_cmp_ge_u32 s62, s63
    s_cbranch_scc1 L_dp_101
    s_waitcnt vmcnt(6)
L_dp_101:
    s_add_u32 s30, s37, 544768
    buffer_load_dwordx4 v[184:187], v2, s[12:15], s30 offen nt
    s_waitcnt vmcnt(9)
    s_cbranch_vccnz L_dp_102
    s_waitcnt vmcnt(7)
    s_cmp_ge_u32 s62, s63
    s_cbranch_scc1 L_dp_102
    s_waitcnt vmcnt(4)
L_dp_102:
    s_add_u32 s30, s37, 552960
    buffer_load_dwordx4 v[188:191], v2, s[12:15], s30 offen nt
    s_waitcnt vmcnt(9)
    s_cbranch_vccnz L_dp_103
    s_waitcnt vmcnt(5)
    s_cmp_ge_u32 s62, s63
    s_cbranch_scc1 L_dp_103
    s_waitcnt vmcnt(4)
L_dp_103:
    s_add_u32 s30, s37, 655360
    buffer_load_dwordx4 v[192:195], v2, s[12:15], s30 offen nt
    s_waitcnt vmcnt(9)
    s_cbranch_vccnz L_dp_104
    s_waitcnt vmcnt(5)
    s_cmp_ge_u32 s62, s63
    s_cbranch_scc1 L_dp_104
    s_waitcnt vmcnt(4)
L_dp_104:
    s_add_u32 s30, s37, 663552
    buffer_load_dwordx4 v[196:199], v2, s[12:15], s30 offen nt
    s_waitcnt vmcnt(7)
    s_add_u32 s60, s58, 8
    v_subrev_u32 v7, s60, v7
    v_cmp_gt_u32 vcc, 8, v7
    s_bcnt1_i32_b64 s62, vcc
    s_cmp_ge_u32 s62, s59
    s_cselect_b64 vcc, -1, 0
    s_cbranch_vccnz L_dp_105
    s_waitcnt vmcnt(5)
    s_cmp_ge_u32 s62, s63
    s_cbranch_scc1 L_dp_105
    s_waitcnt vmcnt(4)
L_dp_105:
    s_add_u32 s30, s37, 659456
    buffer_load_dwordx4 v[200:203], v2, s[12:15], s30 offen nt
L_spin_106:
    v_mov_b32 v4, 0
    ds_read_b64 v[4:5], v4 offset:8
    s_waitcnt lgkmcnt(0)
    v_readfirstlane_b32 s31, v4
    s_cmp_ge_u32 s31, 1
    s_cbranch_scc1 L_got_107
    s_add_u32 s33, s33, 1
    s_cmp_lt_u32 s33, 400000
    s_cbranch_scc1 L_spin_106
    s_branch L_exit
L_got_107:
    v_readfirstlane_b32 s28, v5
    s_sub_u32 s75, s31, 1
    v_lshrrev_b32 v4, 1, v0
    v_and_b32 v4, 1, v4
    v_and_b32 v5, 1, v0
    v_lshrrev_b32 v6, 4, v0
    v_lshlrev_b32 v6, 5, v6
    v_lshl_or_b32 v6, v5, 4, v6
    v_lshl_or_b32 v3, v4, 7, v6
    ds_read_b128 v[24:27], v3 offset:2048
    s_waitcnt lgkmcnt(0)
    ds_read_b128 v[28:31], v3 offset:2304
    v_perm_b32 v8, v228, v224, s38
    v_perm_b32 v12, v228, v224, s39
    v_perm_b32 v9, v236, v232, s38
    v_perm_b32 v13, v236, v232, s39
    v_perm_b32 v10, v244, v240, s38
    v_perm_b32 v14, v244, v240, s39
    v_perm_b32 v11, v252, v248, s38
    v_perm_b32 v15, v252, v248, s39
    s_nop 0
    v_mfma_f32_16x16x32_bf16 v[32:35], v[24:27], v[8:11], 0
    v_perm_b32 v16, v229, v225, s38
    v_perm_b32 v20, v229, v225, s39
    v_perm_b32 v17, v237, v233, s38
    v_perm_b32 v21, v237, v233, s39
    v_perm_b32 v18, v245, v241, s38
    v_perm_b32 v22, v245, v241, s39
    v_perm_b32 v19, v253, v249, s38
    v_perm_b32 v23, v253, v249, s39
    v_mfma_f32_16x16x32_bf16 v[36:39], v[24:27], v[12:15], 0
    v_mfma_f32_16x16x32_bf16 v[40:43], v[24:27], v[16:19], 0
    v_perm_b32 v8, v230, v226, s38
    v_perm_b32 v12, v230, v226, s39
    v_perm_b32 v9, v238, v234, s38
    v_perm_b32 v13, v238, v234, s39
    v_perm_b32 v10, v246, v242, s38
    v_perm_b32 v14, v246, v242, s39
    v_perm_b32 v11, v254, v250, s38
    v_perm_b32 v15, v254, v250, s39
    v_mfma_f32_16x16x32_bf16 v[44:47], v[24:27], v[20:23], 0
    v_mfma_f32_16x16x32_bf16 v[48:51], v[24:27], v[8:11], 0
    v_perm_b32 v16, v231, v227, s38
    v_perm_b32 v20, v231, v227, s39
    v_perm_b32 v17, v239, v235, s38
    v_perm_b32 v21, v239, v235, s39
    v_perm_b32 v18, v247, v243, s38
    v_perm_b32 v22, v247, v243, s39
    v_perm_b32 v19, v255, v251, s38
    v_perm_b32 v23, v255, v251, s39
    v_mfma_f32_16x16x32_bf16 v[52:55], v[24:27], v[12:15], 0
    v_mfma_f32_16x16x32_bf16 v[56:59], v[24:27], v[16:19], 0
    v_mfma_f32_16x16x32_bf16 v[60:63], v[24:27], v[20:23], 0
    s_waitcnt vmcnt(7)
    s_cbranch_vccnz L_dp_108
    s_waitcnt vmcnt(5)
    s_cmp_ge_u32 s62, s63
    s_cbranch_scc1 L_dp_108
    s_waitcnt vmcnt(4)
L_dp_108:
    s_add_u32 s30, s37, 667648
    buffer_load_dwordx4 v[204:207], v2, s[12:15], s30 offen nt
    v_lshlrev_b32 v7, 1, v0
    s_add_u32 s60, s58, 9
    v_mov_b32 v4, s60
    buffer_load_ushort v7, v7, s[16:19], s56 offen sc1
    s_mov_b64 exec, 1
    buffer_store_short v4, off, s[16:19], s57
    s_mov_b64 exec, -1
    s_waitcnt lgkmcnt(0)
    ds_read_b128 v[24:27], v3 offset:2560
    v_perm_b32 v8, v68, v64, s38
    v_perm_b32 v12, v68, v64, s39
    v_perm_b32 v9, v76, v72, s38
    v_perm_b32 v13, v76, v72, s39
    v_perm_b32 v10, v84, v80, s38
    v_perm_b32 v14, v84, v80, s39
    v_perm_b32 v11, v92, v88, s38
    v_perm_b32 v15, v92, v88, s39
    s_nop 0
    v_mfma_f32_16x16x32_bf16 v[32:35], v[28:31], v[8:11], v[32:35]
    v_perm_b32 v16, v69, v65, s38
    v_perm_b32 v20, v69, v65, s39
    v_perm_b32 v17, v77, v73, s38
    v_perm_b32 v21, v77, v73, s39
    v_perm_b32 v18, v85, v81, s38
    v_perm_b32 v22, v85, v81, s39
    v_perm_b32 v19, v93, v89, s38
    v_perm_b32 v23, v93, v89, s39
    v_mfma_f32_16x16x32_bf16 v[36:39], v[28:31], v[12:15], v[36:39]
    v_mfma_f32_16x16x32_bf16 v[40:43], v[28:31], v[16:19], v[40:43]
    v_perm_b32 v8, v70, v66, s38
    v_perm_b32 v12, v70, v66, s39
    v_perm_b32 v9, v78, v74, s38
    v_perm_b32 v13, v78, v74, s39
    v_perm_b32 v10, v86, v82, s38
    v_perm_b32 v14, v86, v82, s39
    v_perm_b32 v11, v94, v90, s38
    v_perm_b32 v15, v94, v90, s39
    v_mfma_f32_16x16x32_bf16 v[44:47], v[28:31], v[20:23], v[44:47]
    v_mfma_f32_16x16x32_bf16 v[48:51], v[28:31], v[8:11], v[48:51]
    v_perm_b32 v16, v71, v67, s38
    v_perm_b32 v20, v71, v67, s39
    v_perm_b32 v17, v79, v75, s38
    v_perm_b32 v21, v79, v75, s39
    v_perm_b32 v18, v87, v83, s38
    v_perm_b32 v22, v87, v83, s39
    v_perm_b32 v19, v95, v91, s38
    v_perm_b32 v23, v95, v91, s39
    v_mfma_f32_16x16x32_bf16 v[52:55], v[28:31], v[12:15], v[52:55]
    v_mfma_f32_16x16x32_bf16 v[56:59], v[28:31], v[16:19], v[56:59]
    v_mfma_f32_16x16x32_bf16 v[60:63], v[28:31], v[20:23], v[60:63]
    s_waitcnt vmcnt(9)
    s_cbranch_vccnz L_dp_109
    s_waitcnt vmcnt(7)
    s_cmp_ge_u32 s62, s63
    s_cbranch_scc1 L_dp_109
    s_waitcnt vmcnt(6)
L_dp_109:
    s_add_u32 s30, s37, 671744
    buffer_load_dwordx4 v[208:211], v2, s[12:15], s30 offen nt
    s_lshl2_add_u32 s32, s4, s3
    s_lshl2_add_u32 s32, s32, s6
    s_lshl3_add_u32 s32, s32, s5
    s_lshl_b32 s32, s32, 9
    s_add_u32 s32, s32, 524288
    s_mov_b64 s[8:9], s[66:67]
    s_mov_b64 s[40:41], s[66:67]
    s_mov_b32 s11, 0x20000
    s_mov_b32 s43, 0x20000
    s_cmp_eq_u32 s75, 32
    s_cselect_b32 s10, s18, 0
    s_cselect_b32 s42, 0, s18
    s_waitcnt lgkmcnt(0)
    ds_read_b128 v[28:31], v3 offset:2816
    v_perm_b32 v8, v100, v96, s38
    v_perm_b32 v12, v100, v96, s39
    v_perm_b32 v9, v108, v104, s38
    v_perm_b32 v13, v108, v104, s39
    v_perm_b32 v10, v116, v112, s38
    v_perm_b32 v14, v116, v112, s39
    v_perm_b32 v11, v124, v120, s38
    v_perm_b32 v15, v124, v120, s39
    s_nop 0
    v_mfma_f32_16x16x32_bf16 v[32:35], v[24:27], v[8:11], v[32:35]
    v_perm_b32 v16, v101, v97, s38
    v_perm_b32 v20, v101, v97, s39
    v_perm_b32 v17, v109, v105, s38
    v_perm_b32 v21, v109, v105, s39
    v_perm_b32 v18, v117, v113, s38
    v_perm_b32 v22, v117, v113, s39
    v_perm_b32 v19, v125, v121, s38
    v_perm_b32 v23, v125, v121, s39
    v_mfma_f32_16x16x32_bf16 v[36:39], v[24:27], v[12:15], v[36:39]
    v_mfma_f32_16x16x32_bf16 v[40:43], v[24:27], v[16:19], v[40:43]
    v_perm_b32 v8, v102, v98, s38
    v_perm_b32 v12, v102, v98, s39
    v_perm_b32 v9, v110, v106, s38
    v_perm_b32 v13, v110, v106, s39
    v_perm_b32 v10, v118, v114, s38
    v_perm_b32 v14, v118, v114, s39
    v_perm_b32 v11, v126, v122, s38
    v_perm_b32 v15, v126, v122, s39
    v_mfma_f32_16x16x32_bf16 v[44:47], v[24:27], v[20:23], v[44:47]
    v_mfma_f32_16x16x32_bf16 v[48:51], v[24:27], v[8:11], v[48:51]
    v_perm_b32 v16, v103, v99, s38
    v_perm_b32 v20, v103, v99, s39
    v_perm_b32 v17, v111, v107, s38
    v_perm_b32 v21, v111, v107, s39
    v_perm_b32 v18, v119, v115, s38
    v_perm_b32 v22, v119, v115, s39
    v_perm_b32 v19, v127, v123, s38
    v_perm_b32 v23, v127, v123, s39
    v_mfma_f32_16x16x32_bf16 v[52:55], v[24:27], v[12:15], v[52:55]
    v_mfma_f32_16x16x32_bf16 v[56:59], v[24:27], v[16:19], v[56:59]
    v_mfma_f32_16x16x32_bf16 v[60:63], v[24:27], v[20:23], v[60:63]
    s_waitcnt vmcnt(9)
    s_cbranch_vccnz L_dp_110
    s_waitcnt vmcnt(7)
    s_cmp_ge_u32 s62, s63
    s_cbranch_scc1 L_dp_110
    s_waitcnt vmcnt(6)
L_dp_110:
    s_add_u32 s30, s37, 679936
    buffer_load_dwordx4 v[212:215], v2, s[12:15], s30 offen nt
    s_waitcnt lgkmcnt(0)
    ds_read_b128 v[24:27], v3 offset:3072
    v_perm_b32 v8, v132, v128, s38
    v_perm_b32 v12, v132, v128, s39
    v_perm_b32 v9, v140, v136, s38
    v_perm_b32 v13, v140, v136, s39
    v_perm_b32 v10, v148, v144, s38
    v_perm_b32 v14, v148, v144, s39
    v_perm_b32 v11, v156, v152, s38
    v_perm_b32 v15, v156, v152, s39
    s_nop 0
    v_mfma_f32_16x16x32_bf16 v[32:35], v[28:31], v[8:11], v[32:35]
    v_perm_b32 v16, v133, v129, s38
    v_perm_b32 v20, v133, v129, s39
    v_perm_b32 v17, v141, v137, s38
    v_perm_b32 v21, v141, v137, s39
    v_perm_b32 v18, v149, v145, s38
    v_perm_b32 v22, v149, v145, s39
    v_perm_b32 v19, v157, v153, s38
    v_perm_b32 v23, v157, v153, s39
    v_mfma_f32_16x16x32_bf16 v[36:39], v[28:31], v[12:15], v[36:39]
    v_mfma_f32_16x16x32_bf16 v[40:43], v[28:31], v[16:19], v[40:43]
    v_perm_b32 v8, v134, v130, s38
    v_perm_b32 v12, v134, v130, s39
    v_perm_b32 v9, v142, v138, s38
    v_perm_b32 v13, v142, v138, s39
    v_perm_b32 v10, v150, v146, s38
    v_perm_b32 v14, v150, v146, s39
    v_perm_b32 v11, v158, v154, s38
    v_perm_b32 v15, v158, v154, s39
    v_mfma_f32_16x16x32_bf16 v[44:47], v[28:31], v[20:23], v[44:47]
    v_mfma_f32_16x16x32_bf16 v[48:51], v[28:31], v[8:11], v[48:51]
    v_perm_b32 v16, v135, v131, s38
    v_perm_b32 v20, v135, v131, s39
    v_perm_b32 v17, v143, v139, s38
    v_perm_b32 v21, v143, v139, s39
    v_perm_b32 v18, v151, v147, s38
    v_perm_b32 v22, v151, v147, s39
    v_perm_b32 v19, v159, v155, s38
    v_perm_b32 v23, v159, v155, s39
    v_mfma_f32_16x16x32_bf16 v[52:55], v[28:31], v[12:15], v[52:55]
    v_mfma_f32_16x16x32_bf16 v[56:59], v[28:31], v[16:19], v[56:59]
    v_mfma_f32_16x16x32_bf16 v[60:63], v[28:31], v[20:23], v[60:63]
    s_waitcnt vmcnt(9)
    s_cbranch_vccnz L_dp_111
    s_waitcnt vmcnt(7)
    s_cmp_ge_u32 s62, s63
    s_cbranch_scc1 L_dp_111
    s_waitcnt vmcnt(6)
L_dp_111:
    s_add_u32 s30, s37, 675840
    buffer_load_dwordx4 v[216:219], v2, s[12:15], s30 offen nt
    s_waitcnt vmcnt(9)
    s_cbranch_vccnz L_dp_112
    s_waitcnt vmcnt(7)
    s_cmp_ge_u32 s62, s63
    s_cbranch_scc1 L_dp_112
    s_waitcnt vmcnt(6)
L_dp_112:
    s_add_u32 s30, s37, 684032
    buffer_load_dwordx4 v[220:223], v2, s[12:15], s30 offen nt
    s_waitcnt lgkmcnt(0)
    ds_read_b128 v[28:31], v3 offset:3328
    v_perm_b32 v8, v164, v160, s38
    v_perm_b32 v12, v164, v160, s39
    v_perm_b32 v9, v172, v168, s38
    v_perm_b32 v13, v172, v168, s39
    v_perm_b32 v10, v180, v176, s38
    v_perm_b32 v14, v180, v176, s39
    v_perm_b32 v11, v188, v184, s38
    v_perm_b32 v15, v188, v184, s39
    s_nop 0
    v_mfma_f32_16x16x32_bf16 v[32:35], v[24:27], v[8:11], v[32:35]
    v_perm_b32 v16, v165, v161, s38
    v_perm_b32 v20, v165, v161, s39
    v_perm_b32 v17, v173, v169, s38
    v_perm_b32 v21, v173, v169, s39
    v_perm_b32 v18, v181, v177, s38
    v_perm_b32 v22, v181, v177, s39
    v_perm_b32 v19, v189, v185, s38
    v_perm_b32 v23, v189, v185, s39
    v_mfma_f32_16x16x32_bf16 v[36:39], v[24:27], v[12:15], v[36:39]
    v_mfma_f32_16x16x32_bf16 v[40:43], v[24:27], v[16:19], v[40:43]
    v_perm_b32 v8, v166, v162, s38
    v_perm_b32 v12, v166, v162, s39
    v_perm_b32 v9, v174, v170, s38
    v_perm_b32 v13, v174, v170, s39
    v_perm_b32 v10, v182, v178, s38
    v_perm_b32 v14, v182, v178, s39
    v_perm_b32 v11, v190, v186, s38
    v_perm_b32 v15, v190, v186, s39
    v_mfma_f32_16x16x32_bf16 v[44:47], v[24:27], v[20:23], v[44:47]
    v_mfma_f32_16x16x32_bf16 v[48:51], v[24:27], v[8:11], v[48:51]
    v_perm_b32 v16, v167, v163, s38
    v_perm_b32 v20, v167, v163, s39
    v_perm_b32 v17, v175, v171, s38
    v_perm_b32 v21, v175, v171, s39
    v_perm_b32 v18, v183, v179, s38
    v_perm_b32 v22, v183, v179, s39
    v_perm_b32 v19, v191, v187, s38
    v_perm_b32 v23, v191, v187, s39
    v_mfma_f32_16x16x32_bf16 v[52:55], v[24:27], v[12:15], v[52:55]
    v_mfma_f32_16x16x32_bf16 v[56:59], v[24:27], v[16:19], v[56:59]
    v_mfma_f32_16x16x32_bf16 v[60:63], v[24:27], v[20:23], v[60:63]
    s_waitcnt vmcnt(9)
    s_cbranch_vccnz L_dp_113
    s_waitcnt vmcnt(7)
    s_cmp_ge_u32 s62, s63
    s_cbranch_scc1 L_dp_113
    s_waitcnt vmcnt(6)
L_dp_113:
    s_add_u32 s30, s37, 786432
    buffer_load_dwordx4 v[224:227], v2, s[12:15], s30 offen nt
    s_lshl3_add_u32 s30, s4, s6
    s_mul_i32 s30, s30, 448
    s_add_u32 s30, s30, s5
    s_lshl2_add_u32 s31, s4, s6
    s_sub_u32 s31, s31, 4
    s_movk_i32 s26, 896
    s_movk_i32 s25, 1152
    s_mov_b32 s22, 3670016
    s_mov_b32 s23, 0x20000
    s_cmp_eq_u32 s74, 3
    s_cmovk_i32 s26, 3584
    s_cmovk_i32 s25, 1088
    s_cmov_b32 s22, 1605632
    s_cselect_b64 s[20:21], s[52:53], s[48:49]
    s_cselect_b32 s30, s31, s30
    s_lshl_b32 s30, s30, 7
    s_lshl_b32 s31, s3, 4
    s_mul_i32 s31, s31, s26
    s_add_u32 s68, s30, s31
    s_lshl3_add_u32 s69, s26, s68
    s_add_u32 s70, s68, 229376
    s_add_u32 s71, s69, 229376
    s_lshl_b32 s31, s3, 1
    s_mul_i32 s31, s31, s25
    s_add_u32 m0, s31, 16384
    s_mul_i32 s24, s25, 7
    v_bfe_u32 v4, v0, 1, 3
    v_and_b32 v5, 48, v0
    v_and_b32 v6, 1, v0
    v_lshlrev_b32 v5, 1, v5
    v_lshl_or_b32 v5, v6, 4, v5
    v_mad_u32_u24 v1, v4, s26, v5
    s_waitcnt vmcnt(9)
    s_cbranch_vccnz L_dp_114
    s_waitcnt vmcnt(7)
    s_cmp_ge_u32 s62, s63
    s_cbranch_scc1 L_dp_114
    s_waitcnt vmcnt(4)
L_dp_114:
    s_add_u32 s30, s37, 794624
    buffer_load_dwordx4 v[228:231], v2, s[12:15], s30 offen nt
    s_waitcnt vmcnt(9)
    s_cbranch_vccnz L_dp_115
    s_waitcnt vmcnt(5)
    s_cmp_ge_u32 s62, s63
    s_cbranch_scc1 L_dp_115
    s_waitcnt vmcnt(4)
L_dp_115:
    s_add_u32 s30, s37, 790528
    buffer_load_dwordx4 v[232:235], v2, s[12:15], s30 offen nt
    s_waitcnt vmcnt(9)
    s_cbranch_vccnz L_dp_116
    s_waitcnt vmcnt(5)
    s_cmp_ge_u32 s62, s63
    s_cbranch_scc1 L_dp_116
    s_waitcnt vmcnt(4)
L_dp_116:
    s_add_u32 s30, s37, 798720
    buffer_load_dwordx4 v[236:239], v2, s[12:15], s30 offen nt
    s_waitcnt vmcnt(7)
    s_add_u32 s60, s58, 9
    v_subrev_u32 v7, s60, v7
    v_cmp_gt_u32 vcc, 7, v7
    s_bcnt1_i32_b64 s62, vcc
    s_cmp_ge_u32 s62, s59
    s_cselect_b64 vcc, -1, 0
    s_cbranch_vccnz L_dp_117
    s_waitcnt vmcnt(5)
    s_cmp_ge_u32 s62, s63
    s_cbranch_scc1 L_dp_117
    s_waitcnt vmcnt(4)
L_dp_117:
    s_add_u32 s30, s37, 802816
    buffer_load_dwordx4 v[240:243], v2, s[12:15], s30 offen nt
    s_waitcnt vmcnt(7)
    s_cbranch_vccnz L_dp_118
    s_waitcnt vmcnt(5)
    s_cmp_ge_u32 s62, s63
    s_cbranch_scc1 L_dp_118
    s_waitcnt vmcnt(4)
L_dp_118:
    s_add_u32 s30, s37, 811008
    buffer_load_dwordx4 v[244:247], v2, s[12:15], s30 offen nt
    s_waitcnt vmcnt(7)
    s_cbranch_vccnz L_dp_119
    s_waitcnt vmcnt(5)
    s_cmp_ge_u32 s62, s63
    s_cbranch_scc1 L_dp_119
    s_waitcnt vmcnt(4)
L_dp_119:
    s_add_u32 s30, s37, 806912
    buffer_load_dwordx4 v[248:251], v2, s[12:15], s30 offen nt
    s_waitcnt vmcnt(7)
    s_cbranch_vccnz L_dp_120
    s_waitcnt vmcnt(5)
    s_cmp_ge_u32 s62, s63
    s_cbranch_scc1 L_dp_120
    s_waitcnt vmcnt(4)
L_dp_120:
    s_add_u32 s30, s37, 815104
    buffer_load_dwordx4 v[252:255], v2, s[12:15], s30 offen nt
    s_waitcnt lgkmcnt(0)
    ds_read_b128 v[24:27], v3 offset:3584
    v_perm_b32 v8, v196, v192, s38
    v_perm_b32 v12, v196, v192, s39
    v_perm_b32 v9, v204, v200, s38
    v_perm_b32 v13, v204, v200, s39
    v_perm_b32 v10, v212, v208, s38
    v_perm_b32 v14, v212, v208, s39
    v_perm_b32 v11, v220, v216, s38
    v_perm_b32 v15, v220, v216, s39
    s_nop 0
    v_mfma_f32_16x16x32_bf16 v[32:35], v[28:31], v[8:11], v[32:35]
    v_perm_b32 v16, v197, v193, s38
    v_perm_b32 v20, v197, v193, s39
    v_perm_b32 v17, v205, v201, s38
    v_perm_b32 v21, v205, v201, s39
    v_perm_b32 v18, v213, v209, s38
    v_perm_b32 v22, v213, v209, s39
    v_perm_b32 v19, v221, v217, s38
    v_perm_b32 v23, v221, v217, s39
    v_mfma_f32_16x16x32_bf16 v[36:39], v[28:31], v[12:15], v[36:39]
    v_mfma_f32_16x16x32_bf16 v[40:43], v[28:31], v[16:19], v[40:43]
    v_perm_b32 v8, v198, v194, s38
    v_perm_b32 v12, v198, v194, s39
    v_perm_b32 v9, v206, v202, s38
    v_perm_b32 v13, v206, v202, s39
    v_perm_b32 v10, v214, v210, s38
    v_perm_b32 v14, v214, v210, s39
    v_perm_b32 v11, v222, v218, s38
    v_perm_b32 v15, v222, v218, s39
    v_mfma_f32_16x16x32_bf16 v[44:47], v[28:31], v[20:23], v[44:47]
    v_mfma_f32_16x16x32_bf16 v[48:51], v[28:31], v[8:11], v[48:51]
    v_perm_b32 v16, v199, v195, s38
    v_perm_b32 v20, v199, v195, s39
    v_perm_b32 v17, v207, v203, s38
    v_perm_b32 v21, v207, v203, s39
    v_perm_b32 v18, v215, v211, s38
    v_perm_b32 v22, v215, v211, s39
    v_perm_b32 v19, v223, v219, s38
    v_perm_b32 v23, v223, v219, s39
    v_mfma_f32_16x16x32_bf16 v[52:55], v[28:31], v[12:15], v[52:55]
    v_mfma_f32_16x16x32_bf16 v[56:59], v[28:31], v[16:19], v[56:59]
    v_mfma_f32_16x16x32_bf16 v[60:63], v[28:31], v[20:23], v[60:63]
    s_waitcnt vmcnt(7)
    s_cbranch_vccnz L_dp_121
    s_waitcnt vmcnt(5)
    s_cmp_ge_u32 s62, s63
    s_cbranch_scc1 L_dp_121
    s_waitcnt vmcnt(4)
L_dp_121:
    s_setprio 3
    s_add_u32 s30, s37, 917504
    buffer_load_dwordx4 v[64:67], v2, s[12:15], s30 offen nt
    s_waitcnt vmcnt(7)
    s_cbranch_vccnz L_dp_122
    s_waitcnt vmcnt(5)
    s_cmp_ge_u32 s62, s63
    s_cbranch_scc1 L_dp_122
    s_waitcnt vmcnt(4)
L_dp_122:
    s_add_u32 s30, s37, 925696
    buffer_load_dwordx4 v[68:71], v2, s[12:15], s30 offen nt
    s_waitcnt vmcnt(7)
    s_cbranch_vccnz L_dp_123
    s_waitcnt vmcnt(5)
    s_cmp_ge_u32 s62, s63
    s_cbranch_scc1 L_dp_123
    s_waitcnt vmcnt(4)
L_dp_123:
    s_add_u32 s30, s37, 921600
    buffer_load_dwordx4 v[72:75], v2, s[12:15], s30 offen nt
    s_waitcnt vmcnt(7)
    s_cbranch_vccnz L_dp_124
    s_waitcnt vmcnt(5)
    s_cmp_ge_u32 s62, s63
    s_cbranch_scc1 L_dp_124
    s_waitcnt vmcnt(4)
L_dp_124:
    s_add_u32 s30, s37, 929792
    buffer_load_dwordx4 v[76:79], v2, s[12:15], s30 offen nt
    s_waitcnt vmcnt(7)
    s_cbranch_vccnz L_dp_125
    s_waitcnt vmcnt(5)
    s_cmp_ge_u32 s62, s63
    s_cbranch_scc1 L_dp_125
    s_waitcnt vmcnt(4)
L_dp_125:
    s_add_u32 s30, s37, 933888
    buffer_load_dwordx4 v[80:83], v2, s[12:15], s30 offen nt
    s_waitcnt vmcnt(7)
    s_cbranch_vccnz L_dp_126
    s_waitcnt vmcnt(5)
    s_cmp_ge_u32 s62, s63
    s_cbranch_scc1 L_dp_126
    s_waitcnt vmcnt(4)
L_dp_126:
    s_add_u32 s30, s37, 942080
    buffer_load_dwordx4 v[84:87], v2, s[12:15], s30 offen nt
    s_waitcnt vmcnt(7)
    s_cbranch_vccnz L_dp_127
    s_waitcnt vmcnt(5)
    s_cmp_ge_u32 s62, s63
    s_cbranch_scc1 L_dp_127
    s_waitcnt vmcnt(4)
L_dp_127:
    s_add_u32 s30, s37, 937984
    buffer_load_dwordx4 v[88:91], v2, s[12:15], s30 offen nt
    s_waitcnt vmcnt(7)
    s_cbranch_vccnz L_dp_128
    s_waitcnt vmcnt(5)
    s_cmp_ge_u32 s62, s63
    s_cbranch_scc1 L_dp_128
    s_waitcnt vmcnt(4)
L_dp_128:
    s_add_u32 s30, s37, 946176
    buffer_load_dwordx4 v[92:95], v2, s[12:15], s30 offen nt
    buffer_load_dwordx4 v1, s[20:23], s68 offen nt lds
    s_add_u32 m0, m0, s25
    s_nop 0
    buffer_load_dwordx4 v1, s[20:23], s69 offen nt lds
    s_add_u32 m0, m0, s24
    s_nop 0
    buffer_load_dwordx4 v1, s[20:23], s70 offen nt lds
    s_add_u32 m0, m0, s25
    s_nop 0
    buffer_load_dwordx4 v1, s[20:23], s71 offen nt lds
    v_mov_b32 v4, 0
    v_mov_b32 v5, 16
    s_mov_b64 exec, 1
    ds_add_u32 v4, v5 offset:36
    s_mov_b64 exec, -1
    s_waitcnt lgkmcnt(0)
    ds_read_b128 v[28:31], v3 offset:3840
    v_perm_b32 v8, v228, v224, s38
    v_perm_b32 v12, v228, v224, s39
    v_perm_b32 v9, v236, v232, s38
    v_perm_b32 v13, v236, v232, s39
    v_perm_b32 v10, v244, v240, s38
    v_perm_b32 v14, v244, v240, s39
    v_perm_b32 v11, v252, v248, s38
    v_perm_b32 v15, v252, v248, s39
    s_nop 0
    v_mfma_f32_16x16x32_bf16 v[32:35], v[24:27], v[8:11], v[32:35]
    v_perm_b32 v16, v229, v225, s38
    v_perm_b32 v20, v229, v225, s39
    v_perm_b32 v17, v237, v233, s38
    v_perm_b32 v21, v237, v233, s39
    v_perm_b32 v18, v245, v241, s38
    v_perm_b32 v22, v245, v241, s39
    v_perm_b32 v19, v253, v249, s38
    v_perm_b32 v23, v253, v249, s39
    v_mfma_f32_16x16x32_bf16 v[36:39], v[24:27], v[12:15], v[36:39]
    v_mfma_f32_16x16x32_bf16 v[40:43], v[24:27], v[16:19], v[40:43]
    v_perm_b32 v8, v230, v226, s38
    v_perm_b32 v12, v230, v226, s39
    v_perm_b32 v9, v238, v234, s38
    v_perm_b32 v13, v238, v234, s39
    v_perm_b32 v10, v246, v242, s38
    v_perm_b32 v14, v246, v242, s39
    v_perm_b32 v11, v254, v250, s38
    v_perm_b32 v15, v254, v250, s39
    v_mfma_f32_16x16x32_bf16 v[44:47], v[24:27], v[20:23], v[44:47]
    v_mfma_f32_16x16x32_bf16 v[48:51], v[24:27], v[8:11], v[48:51]
    v_perm_b32 v16, v231, v227, s38
    v_perm_b32 v20, v231, v227, s39
    v_perm_b32 v17, v239, v235, s38
    v_perm_b32 v21, v239, v235, s39
    v_perm_b32 v18, v247, v243, s38
    v_perm_b32 v22, v247, v243, s39
    v_perm_b32 v19, v255, v251, s38
    v_perm_b32 v23, v255, v251, s39
    v_mfma_f32_16x16x32_bf16 v[52:55], v[24:27], v[12:15], v[52:55]
    v_mfma_f32_16x16x32_bf16 v[56:59], v[24:27], v[16:19], v[56:59]
    v_mfma_f32_16x16x32_bf16 v[60:63], v[24:27], v[20:23], v[60:63]
    v_and_b32 v8, 7, v0
    v_lshlrev_b32 v8, 4, v8
    v_and_b32 v9, 8, v0
    v_lshl_or_b32 v8, v9, 5, v8
    v_and_b32 v9, 16, v0
    v_lshl_or_b32 v8, v9, 3, v8
    v_and_b32 v9, 32, v0
    v_lshl_or_b32 v8, v9, 25, v8
    s_movk_i32 s31, 0xff
    v_and_b32 v9, 3, v0
    v_mul_u32_u24 v9, 7, v9
    v_lshrrev_b32 v9, v9, s28
    v_and_b32 v9, 0xff, v9
    v_bfi_b32 v9, 1, s28, v9
    s_waitcnt vmcnt(10)
    v_perm_b32 v128, v68, v64, s38
    v_perm_b32 v132, v68, v64, s39
    v_perm_b32 v136, v69, v65, s38
    v_perm_b32 v140, v69, v65, s39
    v_perm_b32 v144, v70, v66, s38
    v_perm_b32 v148, v70, v66, s39
    v_perm_b32 v152, v71, v67, s38
    v_perm_b32 v156, v71, v67, s39
    s_waitcnt vmcnt(8)
    v_perm_b32 v129, v76, v72, s38
    v_perm_b32 v133, v76, v72, s39
    v_perm_b32 v137, v77, v73, s38
    v_perm_b32 v141, v77, v73, s39
    v_perm_b32 v145, v78, v74, s38
    v_perm_b32 v149, v78, v74, s39
    v_perm_b32 v153, v79, v75, s38
    v_perm_b32 v157, v79, v75, s39
    s_waitcnt vmcnt(6)
    v_perm_b32 v130, v84, v80, s38
    v_perm_b32 v134, v84, v80, s39
    v_perm_b32 v138, v85, v81, s38
    v_perm_b32 v142, v85, v81, s39
    v_perm_b32 v146, v86, v82, s38
    v_perm_b32 v150, v86, v82, s39
    v_perm_b32 v154, v87, v83, s38
    v_perm_b32 v158, v87, v83, s39
    s_waitcnt vmcnt(4)
    s_waitcnt lgkmcnt(0)
    v_perm_b32 v131, v92, v88, s38
    v_perm_b32 v135, v92, v88, s39
    v_perm_b32 v139, v93, v89, s38
    v_perm_b32 v143, v93, v89, s39
    v_mfma_f32_16x16x32_bf16 v[32:35], v[28:31], v[128:131], v[32:35]
    v_perm_b32 v147, v94, v90, s38
    v_perm_b32 v151, v94, v90, s39
    v_mfma_f32_16x16x32_bf16 v[36:39], v[28:31], v[132:135], v[36:39]
    v_perm_b32 v155, v95, v91, s38
    v_perm_b32 v159, v95, v91, s39
    v_mfma_f32_16x16x32_bf16 v[40:43], v[28:31], v[136:139], v[40:43]
    v_mfma_f32_16x16x32_bf16 v[44:47], v[28:31], v[140:143], v[44:47]
    v_mfma_f32_16x16x32_bf16 v[48:51], v[28:31], v[144:147], v[48:51]
    v_add_f32_dpp v4, v33, v32 row_ror:8 row_mask:0x1 bank_mask:0x3
    v_add_f32_dpp v4, v34, v35 row_ror:8 row_mask:0x1 bank_mask:0xc
    v_mfma_f32_16x16x32_bf16 v[52:55], v[28:31], v[148:151], v[52:55]
    v_add_f32_dpp v5, v37, v36 row_ror:8 row_mask:0x1 bank_mask:0x3
    v_add_f32_dpp v5, v38, v39 row_ror:8 row_mask:0x1 bank_mask:0xc
    v_mfma_f32_16x16x32_bf16 v[56:59], v[28:31], v[152:155], v[56:59]
    v_add_f32_dpp v6, v41, v40 row_ror:8 row_mask:0x1 bank_mask:0x3
    v_add_f32_dpp v6, v42, v43 row_ror:8 row_mask:0x1 bank_mask:0xc
    v_mfma_f32_16x16x32_bf16 v[60:63], v[28:31], v[156:159], v[60:63]
    v_add_f32_dpp v7, v45, v44 row_ror:8 row_mask:0x1 bank_mask:0x3
    v_add_f32_dpp v7, v46, v47 row_ror:8 row_mask:0x1 bank_mask:0xc
    v_add_f32_dpp v4, v49, v48 row_ror:8 row_mask:0x2 bank_mask:0x3
    v_add_f32_dpp v4, v50, v51 row_ror:8 row_mask:0x2 bank_mask:0xc
    v_add_f32_dpp v5, v53, v52 row_ror:8 row_mask:0x2 bank_mask:0x3
    v_add_f32_dpp v5, v54, v55 row_ror:8 row_mask:0x2 bank_mask:0xc
    v_add_f32_dpp v6, v57, v56 row_ror:8 row_mask:0x2 bank_mask:0x3
    v_add_f32_dpp v6, v58, v59 row_ror:8 row_mask:0x2 bank_mask:0xc
    v_add_f32_dpp v7, v61, v60 row_ror:8 row_mask:0x2 bank_mask:0x3
    v_add_f32_dpp v7, v62, v63 row_ror:8 row_mask:0x2 bank_mask:0xc
    v_bfi_b32 v4, s31, v9, v4
    s_mov_b32 exec_hi, 0
    buffer_store_dwordx4 v[4:7], v8, s[8:11], s32 offen
    buffer_store_dwordx4 v[4:7], v8, s[40:43], s32 offen sc1
    s_mov_b32 exec_hi, -1
    s_cmp_eq_u32 s74, 3
    s_cbranch_scc1 L_fs
    s_waitcnt vmcnt(2)
    s_barrier
    s_barrier
    s_branch L_exit
L_fs:
    s_barrier
    s_waitcnt vmcnt(0)
    v_mov_b32 v12, 0
    v_mov_b32 v13, 1
    s_mov_b64 exec, 1
    ds_add_u32 v12, v13 offset:28
    s_mov_b64 exec, -1
    s_cmp_lt_u32 s3, 3
    s_cbranch_scc1 L_fhelp
    s_branch L_exit
L_chain:
    s_setprio 2
    s_mov_b32 s33, 0
    s_lshl2_add_u32 s34, s4, s6
    s_and_b32 s29, s3, 3
    s_and_b32 s31, s7, 7
    s_lshl3_add_u32 s30, s4, s31
    s_cmp_lt_u32 s2, 42
    s_cselect_b32 s30, s2, s30
    v_bfe_u32 v1, v0, 1, 3
    v_lshrrev_b32 v10, 4, v0
    v_and_b32 v11, 1, v0
    v_lshlrev_b32 v11, 4, v11
    v_lshl_or_b32 v2, v10, 5, v11
    v_lshlrev_b32 v5, 4, v0
    v_and_b32 v11, 7, v0
    v_lshrrev_b32 v12, 3, v0
    v_lshlrev_b32 v13, 4, v11
    v_mul_u32_u24 v6, 896, v11
    v_lshl_add_u32 v6, v12, 4, v6
    v_lshl_or_b32 v7, v12, 8, v13
    v_lshl_or_b32 v4, v10, 7, v13
    s_add_u32 s72, s29, 4
    s_min_u32 s72, s72, 6
    s_and_b32 s31, s5, 4
    s_lshl_b32 s31, s31, 15
    s_add_u32 s31, s31, 3145728
    s_cmp_eq_u32 s74, 1
    s_cselect_b32 s31, 4096, s31
    s_lshl_b32 s73, s30, 11
    s_add_u32 s73, s73, s31
    s_lshl_b32 s31, s29, 9
    s_add_u32 s73, s73, s31
    s_lshl_b32 s30, s29, 7
    s_lshl_b32 s31, s72, 7
    v_mov_b32 v13, 0
    s_mov_b32 s22, 7168
    s_mov_b32 s23, 0x20000
    s_mov_b32 s16, s66
    s_mov_b32 s17, s67
    s_mov_b32 s18, 4194304
    s_mov_b32 s19, 0x20000
    s_cmp_eq_u32 s74, 1
    s_cselect_b64 s[20:21], s[58:59], s[40:41]
    s_cmp_eq_u32 s7, 6
    s_cbranch_scc0 L_np_129
    s_getpc_b64 s[24:25]
L_pc0:
    s_sub_u32 s24, s24, L_pc0-adaLN_cond__sliding_block_cached__glu_gated_swiglu__decode_kernel
    s_subb_u32 s25, s25, 0
    s_lshl_b32 s26, s29, 13
    v_lshl_add_u32 v12, v0, 7, s26
    v_min_u32 v12, L_end-adaLN_cond__sliding_block_cached__glu_gated_swiglu__decode_kernel, v12
    global_load_dword v15, v12, s[24:25]
L_np_129:
    s_load_dword s28, s[66:67], 0
    s_cmp_ge_u32 s2, 14
    s_cbranch_scc0 L_xl
L_spin_130:
    v_mov_b32 v14, 0
    ds_read_b32 v14, v14 offset:24
    s_waitcnt lgkmcnt(0)
    v_readfirstlane_b32 s31, v14
    s_cmp_ge_u32 s31, 4
    s_cbranch_scc1 L_got_131
    s_add_u32 s33, s33, 1
    s_cmp_lt_u32 s33, 400000
    s_cbranch_scc1 L_spin_130
    s_branch L_exit
L_got_131:
L_xl:
    s_lshl_b32 s26, s72, 7
    s_bitcmp1_b32 6, s74
    s_cbranch_scc0 L_c0
    buffer_load_dwordx4 v[228:231], v6, s[20:23], s30 offen
    buffer_load_dwordx4 v[232:235], v6, s[20:23], s26 offen
L_c0:
    v_mul_u32_u24 v3, 1152, v10
    v_and_b32 v13, 15, v0
    v_lshl_add_u32 v3, v13, 3, v3
    s_lshl_b32 s26, s29, 8
    s_add_u32 s26, s26, 16384
    v_add_u32 v3, s26, v3
    s_mov_b32 s36, 0x00ff00ff
    s_mov_b32 s37, 0x00ff00ff
    v_mov_b32 v85, 0
    s_waitcnt vmcnt(0) lgkmcnt(0)
    s_add_u32 s28, s28, 1
    s_getreg_b32 s71, hwreg(HW_REG_XCC_ID, 0, 3)
    s_lshl_b32 s71, s71, 29
    s_and_b32 s30, s28, 0x1fffffff
    s_or_b32 s71, s71, s30
    s_cmp_eq_u32 s29, 1
    s_cbranch_scc0 L_c1
    s_lshl_b32 s30, s4, 8
    s_lshl_b32 s31, s7, 2
    s_add_u32 s30, s30, s31
    s_add_u32 s30, s30, 327680
    v_mov_b32 v12, 0
    v_mov_b32 v14, s71
    s_mov_b64 exec, 1
    buffer_store_dword v14, v12, s[16:19], s30 offen
    s_mov_b64 exec, -1
L_c1:
    s_cmp_eq_u32 s74, 0
    s_cbranch_scc1 L_mid
    s_cmp_eq_u32 s74, 3
    s_cbranch_scc1 L_gemm0
    v_lshlrev_b32 v12, 16, v228
    v_and_b32 v13, 0xffff0000, v228
    v_lshlrev_b32 v14, 16, v229
    v_and_b32 v15, 0xffff0000, v229
    v_lshlrev_b32 v16, 16, v230
    v_and_b32 v17, 0xffff0000, v230
    v_lshlrev_b32 v18, 16, v231
    v_and_b32 v19, 0xffff0000, v231
    v_lshlrev_b32 v20, 16, v232
    v_and_b32 v21, 0xffff0000, v232
    v_lshlrev_b32 v22, 16, v233
    v_and_b32 v23, 0xffff0000, v233
    v_lshlrev_b32 v24, 16, v234
    v_and_b32 v25, 0xffff0000, v234
    v_lshlrev_b32 v26, 16, v235
    v_and_b32 v27, 0xffff0000, v235
    s_cmp_eq_u32 s74, 2
    s_cbranch_scc1 L_actQ
    s_mov_b32 s26, 0xbfb8aa3b
    v_mul_f32 v28, s26, v12
    v_mul_f32 v29, s26, v13
    v_mul_f32 v30, s26, v14
    v_mul_f32 v31, s26, v15
    v_mul_f32 v32, s26, v16
    v_mul_f32 v33, s26, v17
    v_mul_f32 v34, s26, v18
    v_mul_f32 v35, s26, v19
    v_mul_f32 v36, s26, v20
    v_mul_f32 v37, s26, v21
    v_mul_f32 v38, s26, v22
    v_mul_f32 v39, s26, v23
    v_mul_f32 v40, s26, v24
    v_mul_f32 v41, s26, v25
    v_mul_f32 v42, s26, v26
    v_mul_f32 v43, s26, v27
    v_exp_f32 v28, v28
    v_exp_f32 v29, v29
    v_exp_f32 v30, v30
    v_exp_f32 v31, v31
    v_exp_f32 v32, v32
    v_exp_f32 v33, v33
    v_exp_f32 v34, v34
    v_exp_f32 v35, v35
    v_exp_f32 v36, v36
    v_exp_f32 v37, v37
    v_exp_f32 v38, v38
    v_exp_f32 v39, v39
    v_exp_f32 v40, v40
    v_exp_f32 v41, v41
    v_exp_f32 v42, v42
    v_exp_f32 v43, v43
    v_add_f32 v28, 1.0, v28
    v_add_f32 v29, 1.0, v29
    v_add_f32 v30, 1.0, v30
    v_add_f32 v31, 1.0, v31
    v_add_f32 v32, 1.0, v32
    v_add_f32 v33, 1.0, v33
    v_add_f32 v34, 1.0, v34
    v_add_f32 v35, 1.0, v35
    v_add_f32 v36, 1.0, v36
    v_add_f32 v37, 1.0, v37
    v_add_f32 v38, 1.0, v38
    v_add_f32 v39, 1.0, v39
    v_add_f32 v40, 1.0, v40
    v_add_f32 v41, 1.0, v41
    v_add_f32 v42, 1.0, v42
    v_add_f32 v43, 1.0, v43
    s_mov_b32 s27, 0x7f7fffff
    v_min_f32 v28, s27, v28
    v_min_f32 v29, s27, v29
    v_min_f32 v30, s27, v30
    v_min_f32 v31, s27, v31
    v_min_f32 v32, s27, v32
    v_min_f32 v33, s27, v33
    v_min_f32 v34, s27, v34
    v_min_f32 v35, s27, v35
    v_min_f32 v36, s27, v36
    v_min_f32 v37, s27, v37
    v_min_f32 v38, s27, v38
    v_min_f32 v39, s27, v39
    v_min_f32 v40, s27, v40
    v_min_f32 v41, s27, v41
    v_min_f32 v42, s27, v42
    v_min_f32 v43, s27, v43
    v_rcp_f32 v44, v28
    v_rcp_f32 v45, v29
    v_rcp_f32 v46, v30
    v_rcp_f32 v47, v31
    v_rcp_f32 v48, v32
    v_rcp_f32 v49, v33
    v_rcp_f32 v50, v34
    v_rcp_f32 v51, v35
    v_rcp_f32 v52, v36
    v_rcp_f32 v53, v37
    v_rcp_f32 v54, v38
    v_rcp_f32 v55, v39
    v_rcp_f32 v56, v40
    v_rcp_f32 v57, v41
    v_rcp_f32 v58, v42
    v_rcp_f32 v59, v43
    v_pk_mul_f32 v[60:61], v[12:13], v[44:45]
    v_pk_mul_f32 v[62:63], v[14:15], v[46:47]
    v_pk_mul_f32 v[64:65], v[16:17], v[48:49]
    v_pk_mul_f32 v[66:67], v[18:19], v[50:51]
    v_pk_mul_f32 v[68:69], v[20:21], v[52:53]
    v_pk_mul_f32 v[70:71], v[22:23], v[54:55]
    v_pk_mul_f32 v[72:73], v[24:25], v[56:57]
    v_pk_mul_f32 v[74:75], v[26:27], v[58:59]
    v_pk_fma_f32 v[12:13], v[60:61], v[28:29], v[12:13] neg_lo:[1,0,0] neg_hi:[1,0,0]
    v_pk_fma_f32 v[14:15], v[62:63], v[30:31], v[14:15] neg_lo:[1,0,0] neg_hi:[1,0,0]
    v_pk_fma_f32 v[16:17], v[64:65], v[32:33], v[16:17] neg_lo:[1,0,0] neg_hi:[1,0,0]
    v_pk_fma_f32 v[18:19], v[66:67], v[34:35], v[18:19] neg_lo:[1,0,0] neg_hi:[1,0,0]
    v_pk_fma_f32 v[20:21], v[68:69], v[36:37], v[20:21] neg_lo:[1,0,0] neg_hi:[1,0,0]
    v_pk_fma_f32 v[22:23], v[70:71], v[38:39], v[22:23] neg_lo:[1,0,0] neg_hi:[1,0,0]
    v_pk_fma_f32 v[24:25], v[72:73], v[40:41], v[24:25] neg_lo:[1,0,0] neg_hi:[1,0,0]
    v_pk_fma_f32 v[26:27], v[74:75], v[42:43], v[26:27] neg_lo:[1,0,0] neg_hi:[1,0,0]
    v_pk_fma_f32 v[12:13], v[12:13], v[44:45], v[60:61]
    v_pk_fma_f32 v[14:15], v[14:15], v[46:47], v[62:63]
    v_pk_fma_f32 v[16:17], v[16:17], v[48:49], v[64:65]
    v_pk_fma_f32 v[18:19], v[18:19], v[50:51], v[66:67]
    v_pk_fma_f32 v[20:21], v[20:21], v[52:53], v[68:69]
    v_pk_fma_f32 v[22:23], v[22:23], v[54:55], v[70:71]
    v_pk_fma_f32 v[24:25], v[24:25], v[56:57], v[72:73]
    v_pk_fma_f32 v[26:27], v[26:27], v[58:59], v[74:75]
    s_branch L_actW
L_actQ:
    v_lshrrev_b32 v47, 5, v0
    v_and_b32 v45, 0x70, v4
    v_lshl_or_b32 v47, v47, 7, v45
    s_lshl_b32 s30, s29, 2
    v_add_u32 v47, s30, v47
    s_cmp_eq_u32 s29, 3
    s_cselect_b32 s30, 0, 1.0
    v_mov_b32 v44, s30
    v_pk_add_f32 v[28:29], v[12:13], v[14:15]
    v_pk_mul_f32 v[30:31], v[12:13], v[12:13]
    v_pk_add_f32 v[32:33], v[16:17], v[18:19]
    v_pk_add_f32 v[34:35], v[20:21], v[22:23]
    v_pk_mul_f32 v[36:37], v[20:21], v[20:21]
    v_pk_add_f32 v[38:39], v[24:25], v[26:27]
    v_pk_fma_f32 v[30:31], v[14:15], v[14:15], v[30:31]
    v_pk_add_f32 v[28:29], v[28:29], v[32:33]
    v_pk_fma_f32 v[36:37], v[22:23], v[22:23], v[36:37]
    v_pk_add_f32 v[34:35], v[34:35], v[38:39]
    v_pk_fma_f32 v[30:31], v[16:17], v[16:17], v[30:31]
    v_pk_fma_f32 v[36:37], v[24:25], v[24:25], v[36:37]
    v_pk_fma_f32 v[30:31], v[18:19], v[18:19], v[30:31]
    v_pk_fma_f32 v[36:37], v[26:27], v[26:27], v[36:37]
    v_pk_fma_f32 v[28:29], v[34:35], v[44:45], v[28:29] op_sel_hi:[1,0,1]
    v_pk_fma_f32 v[30:31], v[36:37], v[44:45], v[30:31] op_sel_hi:[1,0,1]
    v_add_f32 v28, v28, v29
    v_add_f32 v30, v30, v31
    s_nop 1
    v_permlane32_swap_b32 v28, v30
    v_add_f32 v28, v28, v30
    v_mov_b32 v30, v28
    s_nop 1
    v_permlane16_swap_b32 v28, v30
    v_add_f32 v28, v28, v30
    s_nop 1
    v_add_f32_dpp v28, v28, v28 row_ror:8 row_mask:0xf bank_mask:0xf
    ds_write_b32 v47, v28 offset:256
    s_waitcnt lgkmcnt(0)
    v_mov_b32 v10, 0
    v_mov_b32 v11, 1
    s_mov_b64 exec, 1
    ds_add_u32 v10, v11 offset:32
    s_mov_b64 exec, -1
L_spin_132:
    v_mov_b32 v10, 0
    ds_read_b32 v10, v10 offset:32
    s_waitcnt lgkmcnt(0)
    v_readfirstlane_b32 s31, v10
    s_cmp_ge_u32 s31, 4
    s_cbranch_scc1 L_got_133
    s_add_u32 s33, s33, 1
    s_cmp_lt_u32 s33, 400000
    s_cbranch_scc1 L_spin_132
    s_branch L_exit
L_got_133:
    ds_read_b128 v[28:31], v45 offset:256
    ds_read_b128 v[32:35], v45 offset:384
    s_waitcnt lgkmcnt(0)
    v_pk_add_f32 v[28:29], v[28:29], v[30:31]
    v_pk_add_f32 v[32:33], v[32:33], v[34:35]
    v_add_f32 v28, v28, v29
    v_add_f32 v30, v32, v33
    v_mul_f32 v28, 0x3b124925, v28
    v_mul_f32 v30, 0x3b124925, v30
    v_fma_f32 v30, -v28, v28, v30
    v_max_f32 v30, 0, v30
    v_cvt_pk_bf16_f32 v28, 0, v28
    v_cvt_pk_bf16_f32 v30, 0, v30
    v_add_f32 v30, 0x3727c5ac, v30
    v_cvt_pk_bf16_f32 v30, 0, v30
    v_sqrt_f32 v30, v30
    s_nop 0
    v_cvt_pk_bf16_f32 v31, 0, v30
    v_rcp_f32 v30, v31
    s_cmp_lt_u32 s5, 4
    s_cselect_b32 s72, s29, s72
    s_cbranch_scc1 L_qh0
    v_mov_b32 v12, v20
    v_mov_b32 v13, v21
    v_mov_b32 v14, v22
    v_mov_b32 v15, v23
    v_mov_b32 v16, v24
    v_mov_b32 v17, v25
    v_mov_b32 v18, v26
    v_mov_b32 v19, v27
L_qh0:
    v_pk_add_f32 v[12:13], v[12:13], v[28:29] op_sel_hi:[1,0] neg_lo:[0,1] neg_hi:[0,1]
    v_pk_add_f32 v[14:15], v[14:15], v[28:29] op_sel_hi:[1,0] neg_lo:[0,1] neg_hi:[0,1]
    v_pk_add_f32 v[16:17], v[16:17], v[28:29] op_sel_hi:[1,0] neg_lo:[0,1] neg_hi:[0,1]
    v_pk_add_f32 v[18:19], v[18:19], v[28:29] op_sel_hi:[1,0] neg_lo:[0,1] neg_hi:[0,1]
    v_cvt_pk_bf16_f32 v12, 0, v12
    v_cvt_pk_bf16_f32 v13, 0, v13
    v_cvt_pk_bf16_f32 v14, 0, v14
    v_cvt_pk_bf16_f32 v15, 0, v15
    v_cvt_pk_bf16_f32 v16, 0, v16
    v_cvt_pk_bf16_f32 v17, 0, v17
    v_cvt_pk_bf16_f32 v18, 0, v18
    v_cvt_pk_bf16_f32 v19, 0, v19
    v_pk_mul_f32 v[44:45], v[12:13], v[30:31] op_sel_hi:[1,0]
    v_pk_mul_f32 v[46:47], v[14:15], v[30:31] op_sel_hi:[1,0]
    v_pk_mul_f32 v[48:49], v[16:17], v[30:31] op_sel_hi:[1,0]
    v_pk_mul_f32 v[50:51], v[18:19], v[30:31] op_sel_hi:[1,0]
    v_pk_fma_f32 v[12:13], v[44:45], v[30:31], v[12:13] op_sel:[0,1,0] op_sel_hi:[1,1,1] neg_lo:[1,0,0] neg_hi:[1,0,0]
    v_pk_fma_f32 v[14:15], v[46:47], v[30:31], v[14:15] op_sel:[0,1,0] op_sel_hi:[1,1,1] neg_lo:[1,0,0] neg_hi:[1,0,0]
    v_pk_fma_f32 v[16:17], v[48:49], v[30:31], v[16:17] op_sel:[0,1,0] op_sel_hi:[1,1,1] neg_lo:[1,0,0] neg_hi:[1,0,0]
    v_pk_fma_f32 v[18:19], v[50:51], v[30:31], v[18:19] op_sel:[0,1,0] op_sel_hi:[1,1,1] neg_lo:[1,0,0] neg_hi:[1,0,0]
    v_pk_fma_f32 v[12:13], v[12:13], v[30:31], v[44:45] op_sel_hi:[1,0,1]
    v_pk_fma_f32 v[14:15], v[14:15], v[30:31], v[46:47] op_sel_hi:[1,0,1]
    v_pk_fma_f32 v[16:17], v[16:17], v[30:31], v[48:49] op_sel_hi:[1,0,1]
    v_pk_fma_f32 v[18:19], v[18:19], v[30:31], v[50:51] op_sel_hi:[1,0,1]
    v_cvt_pk_bf16_f32 v12, 0, v12
    v_cvt_pk_bf16_f32 v13, 0, v13
    v_cvt_pk_bf16_f32 v14, 0, v14
    v_cvt_pk_bf16_f32 v15, 0, v15
    v_cvt_pk_bf16_f32 v16, 0, v16
    v_cvt_pk_bf16_f32 v17, 0, v17
    v_cvt_pk_bf16_f32 v18, 0, v18
    v_cvt_pk_bf16_f32 v19, 0, v19
L_spin_134:
    v_mov_b32 v10, 0
    ds_read_b32 v10, v10 offset:40
    s_waitcnt lgkmcnt(0)
    v_readfirstlane_b32 s31, v10
    s_cmp_ge_u32 s31, 1
    s_cbranch_scc1 L_got_135
    s_add_u32 s33, s33, 1
    s_cmp_lt_u32 s33, 400000
    s_cbranch_scc1 L_spin_134
    s_branch L_exit
L_got_135:
    s_lshl_b32 s30, s4, 8
    s_add_u32 s30, s30, 327680
    v_and_b32 v76, 31, v0
    v_lshlrev_b32 v76, 2, v76
    buffer_load_dword v76, v76, s[16:19], s30 offen sc1
    s_lshl_b32 s24, s72, 11
    s_add_u32 s24, s24, 4096
    s_lshl_b32 s25, s72, 11
    s_add_u32 s25, s25, 18432
    buffer_load_dwordx3 v[144:146], v7, s[16:19], s24 offen offset:0 sc1
    buffer_load_dwordx3 v[148:150], v7, s[16:19], s24 offen offset:128 sc1
    buffer_load_dwordx3 v[152:154], v7, s[16:19], s25 offen offset:0 sc1
    buffer_load_dwordx3 v[156:158], v7, s[16:19], s25 offen offset:128 sc1
    s_branch L_m_136chk
L_m_136poll:
    s_quadmask_b64 s[8:9], s[8:9]
    s_bitreplicate_b64_b32 s[8:9], s8
    s_wqm_b32 s8, s8
    s_bitreplicate_b64_b32 exec, s8
    buffer_load_dwordx3 v[144:146], v7, s[16:19], s24 offen offset:0 sc1
    s_quadmask_b64 s[10:11], s[10:11]
    s_bitreplicate_b64_b32 s[10:11], s10
    s_wqm_b32 s10, s10
    s_bitreplicate_b64_b32 exec, s10
    buffer_load_dwordx3 v[148:150], v7, s[16:19], s24 offen offset:128 sc1
    s_quadmask_b64 s[12:13], s[12:13]
    s_bitreplicate_b64_b32 s[12:13], s12
    s_wqm_b32 s12, s12
    s_bitreplicate_b64_b32 exec, s12
    buffer_load_dwordx3 v[152:154], v7, s[16:19], s25 offen offset:0 sc1
    s_quadmask_b64 s[14:15], s[14:15]
    s_bitreplicate_b64_b32 s[14:15], s14
    s_wqm_b32 s14, s14
    s_bitreplicate_b64_b32 exec, s14
    buffer_load_dwordx3 v[156:158], v7, s[16:19], s25 offen offset:128 sc1
    s_mov_b64 exec, -1
    s_add_u32 s33, s33, 1
    s_cmp_lt_u32 s33, 400000
    s_cbranch_scc0 L_exit
L_m_136chk:
    s_waitcnt vmcnt(0)
    v_cmp_ne_u32_e64 s[8:9], s28, v144
    v_cmp_ne_u32_e64 s[10:11], s28, v148
    v_cmp_ne_u32_e64 s[12:13], s28, v152
    v_cmp_ne_u32_e64 s[14:15], s28, v156
    s_or_b64 vcc, s[8:9], s[10:11]
    s_or_b64 vcc, vcc, s[12:13]
    s_or_b64 vcc, vcc, s[14:15]
    s_cbranch_scc1 L_m_136poll
    v_lshlrev_b32 v28, 16, v145
    v_and_b32 v29, 0xffff0000, v145
    v_lshlrev_b32 v44, 16, v153
    v_and_b32 v45, 0xffff0000, v153
    v_lshlrev_b32 v30, 16, v146
    v_and_b32 v31, 0xffff0000, v146
    v_lshlrev_b32 v46, 16, v154
    v_and_b32 v47, 0xffff0000, v154
    v_lshlrev_b32 v32, 16, v149
    v_and_b32 v33, 0xffff0000, v149
    v_lshlrev_b32 v48, 16, v157
    v_and_b32 v49, 0xffff0000, v157
    v_lshlrev_b32 v34, 16, v150
    v_and_b32 v35, 0xffff0000, v150
    v_lshlrev_b32 v50, 16, v158
    v_and_b32 v51, 0xffff0000, v158
    v_add_f32 v44, 1.0, v44
    v_add_f32 v45, 1.0, v45
    v_add_f32 v46, 1.0, v46
    v_add_f32 v47, 1.0, v47
    v_add_f32 v48, 1.0, v48
    v_add_f32 v49, 1.0, v49
    v_add_f32 v50, 1.0, v50
    v_add_f32 v51, 1.0, v51
    v_cvt_pk_bf16_f32 v44, 0, v44
    v_cvt_pk_bf16_f32 v45, 0, v45
    v_cvt_pk_bf16_f32 v46, 0, v46
    v_cvt_pk_bf16_f32 v47, 0, v47
    v_cvt_pk_bf16_f32 v48, 0, v48
    v_cvt_pk_bf16_f32 v49, 0, v49
    v_cvt_pk_bf16_f32 v50, 0, v50
    v_cvt_pk_bf16_f32 v51, 0, v51
    v_cmp_eq_u32 vcc, s71, v76
    s_bcnt1_i32_b32 s75, vcc_lo
    v_pk_mul_f32 v[12:13], v[12:13], v[44:45]
    v_pk_mul_f32 v[14:15], v[14:15], v[46:47]
    v_pk_mul_f32 v[16:17], v[16:17], v[48:49]
    v_pk_mul_f32 v[18:19], v[18:19], v[50:51]
    v_cvt_pk_bf16_f32 v12, 0, v12
    v_cvt_pk_bf16_f32 v13, 0, v13
    v_cvt_pk_bf16_f32 v14, 0, v14
    v_cvt_pk_bf16_f32 v15, 0, v15
    v_cvt_pk_bf16_f32 v16, 0, v16
    v_cvt_pk_bf16_f32 v17, 0, v17
    v_cvt_pk_bf16_f32 v18, 0, v18
    v_cvt_pk_bf16_f32 v19, 0, v19
    v_pk_add_f32 v[12:13], v[12:13], v[28:29]
    v_pk_add_f32 v[14:15], v[14:15], v[30:31]
    v_pk_add_f32 v[16:17], v[16:17], v[32:33]
    v_pk_add_f32 v[18:19], v[18:19], v[34:35]
    v_cvt_pk_bf16_f32 v12, v12, v13
    v_cvt_pk_bf16_f32 v13, v14, v15
    v_cvt_pk_bf16_f32 v14, v16, v17
    v_cvt_pk_bf16_f32 v15, v18, v19
    s_lshl_b32 s30, s29, 10
    v_add_u32 v10, s30, v5
    ds_write_b128 v10, v[12:15] offset:8192
    s_waitcnt lgkmcnt(0)
    v_mov_b32 v10, 0
    v_mov_b32 v11, 1
    s_mov_b64 exec, 1
    ds_add_u32 v10, v11 offset:24
    s_mov_b64 exec, -1
L_spin_137:
    v_mov_b32 v10, 0
    ds_read_b32 v10, v10 offset:24
    s_waitcnt lgkmcnt(0)
    v_readfirstlane_b32 s31, v10
    s_cmp_ge_u32 s31, 8
    s_cbranch_scc1 L_got_138
    s_add_u32 s33, s33, 1
    s_cmp_lt_u32 s33, 400000
    s_cbranch_scc1 L_spin_137
    s_branch L_exit
L_got_138:
    ds_read_b64_tr_b16 v[88:89], v3 offset:0
    ds_read_b64_tr_b16 v[90:91], v3 offset:128
    ds_read_b64_tr_b16 v[92:93], v3 offset:4608
    ds_read_b64_tr_b16 v[94:95], v3 offset:4736
    ds_read_b64_tr_b16 v[96:97], v3 offset:9216
    ds_read_b64_tr_b16 v[98:99], v3 offset:9344
    ds_read_b64_tr_b16 v[100:101], v3 offset:13824
    ds_read_b64_tr_b16 v[102:103], v3 offset:13952
    ds_read_b64_tr_b16 v[104:105], v3 offset:18432
    ds_read_b64_tr_b16 v[106:107], v3 offset:18560
    ds_read_b64_tr_b16 v[108:109], v3 offset:23040
    ds_read_b64_tr_b16 v[110:111], v3 offset:23168
    ds_read_b64_tr_b16 v[112:113], v3 offset:27648
    ds_read_b64_tr_b16 v[114:115], v3 offset:27776
    ds_read_b64_tr_b16 v[116:117], v3 offset:32256
    ds_read_b64_tr_b16 v[118:119], v3 offset:32384
    ds_read_b128 v[12:15], v4 offset:8192
    ds_read_b128 v[16:19], v4 offset:8704
    ds_read_b128 v[20:23], v4 offset:9216
    ds_read_b128 v[24:27], v4 offset:9728
    ds_read_b128 v[28:31], v4 offset:10240
    ds_read_b128 v[32:35], v4 offset:10752
    ds_read_b128 v[36:39], v4 offset:11264
    ds_read_b128 v[40:43], v4 offset:11776
    s_waitcnt lgkmcnt(0)
    v_mfma_f32_16x16x32_bf16 v[68:71], v[88:91], v[12:15], 0
    v_mfma_f32_16x16x32_bf16 v[68:71], v[92:95], v[16:19], v[68:71]
    v_mfma_f32_16x16x32_bf16 v[68:71], v[96:99], v[20:23], v[68:71]
    v_mfma_f32_16x16x32_bf16 v[68:71], v[100:103], v[24:27], v[68:71]
    v_mfma_f32_16x16x32_bf16 v[68:71], v[104:107], v[28:31], v[68:71]
    v_mfma_f32_16x16x32_bf16 v[68:71], v[108:111], v[32:35], v[68:71]
    v_mfma_f32_16x16x32_bf16 v[68:71], v[112:115], v[36:39], v[68:71]
    v_mfma_f32_16x16x32_bf16 v[68:71], v[116:119], v[40:43], v[68:71]
    v_and_b32 v12, 7, v0
    v_and_b32 v13, 48, v0
    v_lshl_or_b32 v12, v12, 8, v13
    s_lshl_b32 s30, s29, 6
    v_add_u32 v12, s30, v12
    v_and_b32 v35, 3, v0
    v_mul_u32_u24 v35, 6, v35
    v_lshrrev_b32 v35, v35, s28
    v_mov_b32 v32, s28
    v_lshrrev_b32 v33, 2, v35
    v_lshrrev_b32 v34, 4, v35
    v_lshrrev_b32 v35, 6, v35
    ds_write_b128 v12, v[68:71] offset:12288
    s_waitcnt lgkmcnt(0)
    v_mov_b32 v10, 0
    v_mov_b32 v11, 1
    s_mov_b64 exec, 1
    ds_add_u32 v10, v11 offset:36
    s_mov_b64 exec, -1
L_spin_139:
    v_mov_b32 v10, 0
    ds_read_b32 v10, v10 offset:36
    s_waitcnt lgkmcnt(0)
    v_readfirstlane_b32 s31, v10
    s_cmp_ge_u32 s31, 4
    s_cbranch_scc1 L_got_140
    s_add_u32 s33, s33, 1
    s_cmp_lt_u32 s33, 400000
    s_cbranch_scc1 L_spin_139
    s_branch L_exit
L_got_140:
    s_lshl_b32 s30, s29, 9
    v_add_u32 v12, s30, v5
    ds_read_b128 v[72:75], v12 offset:12288
    s_waitcnt lgkmcnt(0)
    v_bfi_b32 v72, 3, v32, v72
    v_bfi_b32 v73, 3, v33, v73
    v_bfi_b32 v74, 3, v34, v74
    v_bfi_b32 v75, 3, v35, v75
    s_mov_b32 exec_hi, 0
    s_cmp_eq_u32 s75, 32
    s_cbranch_scc0 L_st_141
    buffer_store_dwordx4 v[72:75], v5, s[16:19], s73 offen
    s_branch L_std_142
L_st_141:
    buffer_store_dwordx4 v[72:75], v5, s[16:19], s73 offen sc1
L_std_142:
    s_mov_b64 exec, -1
    s_branch L_pub
L_actW:
    v_cvt_pk_bf16_f32 v12, v12, v13
    v_cvt_pk_bf16_f32 v13, v14, v15
    v_cvt_pk_bf16_f32 v14, v16, v17
    v_cvt_pk_bf16_f32 v15, v18, v19
    v_cvt_pk_bf16_f32 v16, v20, v21
    v_cvt_pk_bf16_f32 v17, v22, v23
    v_cvt_pk_bf16_f32 v18, v24, v25
    v_cvt_pk_bf16_f32 v19, v26, v27
    s_lshl_b32 s30, s29, 10
    s_lshl_b32 s31, s72, 10
    v_add_u32 v10, s30, v5
    v_add_u32 v11, s31, v5
    ds_write_b128 v10, v[12:15] offset:8192
    ds_write_b128 v11, v[16:19] offset:8192
L_gemm0:
    s_waitcnt lgkmcnt(0)
    v_mov_b32 v10, 0
    v_mov_b32 v11, 1
    s_mov_b64 exec, 1
    ds_add_u32 v10, v11 offset:24
    s_mov_b64 exec, -1
L_spin_143:
    v_mov_b32 v10, 0
    ds_read_b32 v10, v10 offset:24
    s_waitcnt lgkmcnt(0)
    v_readfirstlane_b32 s31, v10
    s_cmp_ge_u32 s31, 8
    s_cbranch_scc1 L_got_144
    s_add_u32 s33, s33, 1
    s_cmp_lt_u32 s33, 400000
    s_cbranch_scc1 L_spin_143
    s_branch L_exit
L_got_144:
    ds_read_b64_tr_b16 v[88:89], v3 offset:0
    ds_read_b64_tr_b16 v[90:91], v3 offset:128
    ds_read_b64_tr_b16 v[92:93], v3 offset:4608
    ds_read_b64_tr_b16 v[94:95], v3 offset:4736
    ds_read_b64_tr_b16 v[96:97], v3 offset:9216
    ds_read_b64_tr_b16 v[98:99], v3 offset:9344
    ds_read_b64_tr_b16 v[100:101], v3 offset:13824
    ds_read_b64_tr_b16 v[102:103], v3 offset:13952
    ds_read_b64_tr_b16 v[104:105], v3 offset:18432
    ds_read_b64_tr_b16 v[106:107], v3 offset:18560
    ds_read_b64_tr_b16 v[108:109], v3 offset:23040
    ds_read_b64_tr_b16 v[110:111], v3 offset:23168
    ds_read_b64_tr_b16 v[112:113], v3 offset:27648
    ds_read_b64_tr_b16 v[114:115], v3 offset:27776
    ds_read_b64_tr_b16 v[116:117], v3 offset:32256
    ds_read_b64_tr_b16 v[118:119], v3 offset:32384
    ds_read_b64_tr_b16 v[120:121], v3 offset:36864
    ds_read_b64_tr_b16 v[122:123], v3 offset:36992
    ds_read_b64_tr_b16 v[124:125], v3 offset:41472
    ds_read_b64_tr_b16 v[126:127], v3 offset:41600
    ds_read_b64_tr_b16 v[128:129], v3 offset:46080
    ds_read_b64_tr_b16 v[130:131], v3 offset:46208
    ds_read_b64_tr_b16 v[132:133], v3 offset:50688
    ds_read_b64_tr_b16 v[134:135], v3 offset:50816
    ds_read_b64_tr_b16 v[136:137], v3 offset:55296
    ds_read_b64_tr_b16 v[138:139], v3 offset:55424
    ds_read_b64_tr_b16 v[140:141], v3 offset:59904
    ds_read_b64_tr_b16 v[142:143], v3 offset:60032
    s_cmp_eq_u32 s74, 3
    s_cbranch_scc1 L_mid
    ds_read_b128 v[12:15], v4 offset:8192
    ds_read_b128 v[16:19], v4 offset:8704
    ds_read_b128 v[20:23], v4 offset:9216
    ds_read_b128 v[24:27], v4 offset:9728
    ds_read_b128 v[28:31], v4 offset:10240
    ds_read_b128 v[32:35], v4 offset:10752
    ds_read_b128 v[36:39], v4 offset:11264
    ds_read_b128 v[40:43], v4 offset:11776
    ds_read_b128 v[44:47], v4 offset:12288
    ds_read_b128 v[48:51], v4 offset:12800
    ds_read_b128 v[52:55], v4 offset:13312
    ds_read_b128 v[56:59], v4 offset:13824
    ds_read_b128 v[60:63], v4 offset:14336
    ds_read_b128 v[64:67], v4 offset:14848
    s_waitcnt lgkmcnt(0)
    v_mfma_f32_16x16x32_bf16 v[68:71], v[88:91], v[12:15], 0
    v_mfma_f32_16x16x32_bf16 v[68:71], v[92:95], v[16:19], v[68:71]
    v_mfma_f32_16x16x32_bf16 v[68:71], v[96:99], v[20:23], v[68:71]
    v_mfma_f32_16x16x32_bf16 v[68:71], v[100:103], v[24:27], v[68:71]
    v_mfma_f32_16x16x32_bf16 v[68:71], v[104:107], v[28:31], v[68:71]
    v_mfma_f32_16x16x32_bf16 v[68:71], v[108:111], v[32:35], v[68:71]
    v_mfma_f32_16x16x32_bf16 v[68:71], v[112:115], v[36:39], v[68:71]
    v_mfma_f32_16x16x32_bf16 v[68:71], v[116:119], v[40:43], v[68:71]
    v_mfma_f32_16x16x32_bf16 v[68:71], v[120:123], v[44:47], v[68:71]
    v_mfma_f32_16x16x32_bf16 v[68:71], v[124:127], v[48:51], v[68:71]
    v_mfma_f32_16x16x32_bf16 v[68:71], v[128:131], v[52:55], v[68:71]
    v_mfma_f32_16x16x32_bf16 v[68:71], v[132:135], v[56:59], v[68:71]
    v_mfma_f32_16x16x32_bf16 v[68:71], v[136:139], v[60:63], v[68:71]
    v_mfma_f32_16x16x32_bf16 v[68:71], v[140:143], v[64:67], v[68:71]
    v_mov_b32 v72, s28
    v_mov_b32 v75, s28
    s_nop 5
    v_cvt_pk_bf16_f32 v73, v68, v69
    v_cvt_pk_bf16_f32 v74, v70, v71
    s_mov_b64 exec, s[36:37]
    buffer_store_dwordx4 v[72:75], v4, s[16:19], s73 offen sc1
    s_mov_b64 exec, -1
L_pub:
L_mid:
    s_waitcnt lgkmcnt(0)
    v_mov_b32 v12, 0
    v_mov_b32 v13, 1
    s_mov_b64 exec, 1
    ds_add_u32 v12, v13 offset:20
    s_mov_b64 exec, -1
    s_cmp_eq_u32 s29, 0
    s_cbranch_scc0 L_noq
L_spin_145:
    v_mov_b32 v12, 0
    ds_read_b32 v12, v12 offset:16
    s_waitcnt lgkmcnt(0)
    v_readfirstlane_b32 s31, v12
    s_cmp_ge_u32 s31, 1
    s_cbranch_scc1 L_got_146
    s_add_u32 s33, s33, 1
    s_cmp_lt_u32 s33, 400000
    s_cbranch_scc1 L_spin_145
    s_branch L_exit
L_got_146:
    s_lshl_b32 s30, s4, 14
    s_lshl_b32 s31, s5, 8
    s_add_u32 s30, s30, s31
    s_add_u32 s30, s30, 3145728
    s_add_u32 s31, s30, 8192
    v_lshrrev_b32 v12, 4, v0
    v_and_b32 v14, 0xf0, v5
    v_lshl_or_b32 v14, v12, 11, v14
    v_lshlrev_b32 v15, 3, v0
    s_add_u32 s24, s30, 0x20000
    s_add_u32 s25, s31, 0x20000
    v_and_b32 v35, 3, v0
    v_mul_u32_u24 v35, 6, v35
    v_lshrrev_b32 v35, v35, s28
    v_mov_b32 v32, s28
    v_lshrrev_b32 v33, 2, v35
    v_lshrrev_b32 v34, 4, v35
    v_lshrrev_b32 v35, 6, v35
    buffer_load_dwordx4 v[16:19], v14, s[16:19], s30 offen sc1
    buffer_load_dwordx4 v[20:23], v14, s[16:19], s31 offen sc1
    buffer_load_dwordx4 v[24:27], v14, s[16:19], s24 offen sc1
    buffer_load_dwordx4 v[28:31], v14, s[16:19], s25 offen sc1
    s_branch L_qchk
L_qpoll:
    s_quadmask_b64 s[8:9], s[8:9]
    s_bitreplicate_b64_b32 s[8:9], s8
    s_wqm_b32 s8, s8
    s_bitreplicate_b64_b32 exec, s8
    buffer_load_dwordx4 v[16:19], v14, s[16:19], s30 offen sc1
    s_quadmask_b64 s[10:11], s[10:11]
    s_bitreplicate_b64_b32 s[10:11], s10
    s_wqm_b32 s10, s10
    s_bitreplicate_b64_b32 exec, s10
    buffer_load_dwordx4 v[20:23], v14, s[16:19], s31 offen sc1
    s_quadmask_b64 s[12:13], s[12:13]
    s_bitreplicate_b64_b32 s[12:13], s12
    s_wqm_b32 s12, s12
    s_bitreplicate_b64_b32 exec, s12
    buffer_load_dwordx4 v[24:27], v14, s[16:19], s24 offen sc1
    s_quadmask_b64 s[14:15], s[14:15]
    s_bitreplicate_b64_b32 s[14:15], s14
    s_wqm_b32 s14, s14
    s_bitreplicate_b64_b32 exec, s14
    buffer_load_dwordx4 v[28:31], v14, s[16:19], s25 offen sc1
    s_mov_b64 exec, -1
    s_add_u32 s33, s33, 1
    s_cmp_lt_u32 s33, 400000
    s_cbranch_scc0 L_exit
L_qchk:
    s_waitcnt vmcnt(0)
    v_xor_b32 v10, v32, v16
    v_bitop3_b32 v10, v10, v17, v33 bitop3:0xf6
    v_bitop3_b32 v10, v10, v18, v34 bitop3:0xf6
    v_bitop3_b32 v10, v10, v19, v35 bitop3:0xf6
    v_and_b32 v10, 3, v10
    v_cmp_ne_u32_e64 s[8:9], 0, v10
    v_xor_b32 v10, v32, v20
    v_bitop3_b32 v10, v10, v21, v33 bitop3:0xf6
    v_bitop3_b32 v10, v10, v22, v34 bitop3:0xf6
    v_bitop3_b32 v10, v10, v23, v35 bitop3:0xf6
    v_and_b32 v10, 3, v10
    v_cmp_ne_u32_e64 s[10:11], 0, v10
    v_xor_b32 v10, v32, v24
    v_bitop3_b32 v10, v10, v25, v33 bitop3:0xf6
    v_bitop3_b32 v10, v10, v26, v34 bitop3:0xf6
    v_bitop3_b32 v10, v10, v27, v35 bitop3:0xf6
    v_and_b32 v10, 3, v10
    v_cmp_ne_u32_e64 s[12:13], 0, v10
    v_xor_b32 v10, v32, v28
    v_bitop3_b32 v10, v10, v29, v33 bitop3:0xf6
    v_bitop3_b32 v10, v10, v30, v34 bitop3:0xf6
    v_bitop3_b32 v10, v10, v31, v35 bitop3:0xf6
    v_and_b32 v10, 3, v10
    v_cmp_ne_u32_e64 s[14:15], 0, v10
    s_or_b64 vcc, s[8:9], s[10:11]
    s_or_b64 vcc, vcc, s[12:13]
    s_or_b64 vcc, vcc, s[14:15]
    s_cbranch_scc1 L_qpoll
    v_and_b32 v16, -4, v16
    v_and_b32 v17, -4, v17
    v_and_b32 v18, -4, v18
    v_and_b32 v19, -4, v19
    v_and_b32 v20, -4, v20
    v_and_b32 v21, -4, v21
    v_and_b32 v22, -4, v22
    v_and_b32 v23, -4, v23
    v_and_b32 v24, -4, v24
    v_and_b32 v25, -4, v25
    v_and_b32 v26, -4, v26
    v_and_b32 v27, -4, v27
    v_and_b32 v28, -4, v28
    v_and_b32 v29, -4, v29
    v_and_b32 v30, -4, v30
    v_and_b32 v31, -4, v31
    v_pk_add_f32 v[16:17], v[16:17], v[24:25]
    v_pk_add_f32 v[18:19], v[18:19], v[26:27]
    v_pk_add_f32 v[20:21], v[20:21], v[28:29]
    v_pk_add_f32 v[22:23], v[22:23], v[30:31]
    v_cvt_pk_bf16_f32 v16, v16, v17
    v_cvt_pk_bf16_f32 v17, v18, v19
    v_cvt_pk_bf16_f32 v18, v20, v21
    v_cvt_pk_bf16_f32 v19, v22, v23
    ds_write_b64 v15, v[16:17] offset:1024
    ds_write_b64 v15, v[18:19] offset:1536
    s_waitcnt lgkmcnt(0)
    v_mov_b32 v12, 0
    v_mov_b32 v13, 1
    s_mov_b64 exec, 1
    ds_add_u32 v12, v13 offset:0
    s_mov_b64 exec, -1
L_noq:
    s_cmp_eq_u32 s74, 3
    s_cbranch_scc0 L_nofp
L_spin_147:
    v_mov_b32 v12, 0
    ds_read_b32 v12, v12 offset:0
    s_waitcnt lgkmcnt(0)
    v_readfirstlane_b32 s31, v12
    s_cmp_ge_u32 s31, 1
    s_cbranch_scc1 L_got_148
    s_add_u32 s33, s33, 1
    s_cmp_lt_u32 s33, 400000
    s_cbranch_scc1 L_spin_147
    s_branch L_exit
L_got_148:
    s_lshl_b32 s24, s29, 11
    s_add_u32 s24, s24, 47104
    s_lshl_b32 s25, s72, 11
    s_add_u32 s25, s25, 47104
    s_lshl_b32 s26, s29, 11
    s_add_u32 s26, s26, 61440
    s_lshl_b32 s27, s72, 11
    s_add_u32 s27, s27, 61440
    buffer_load_dwordx3 v[144:146], v7, s[16:19], s24 offen offset:0 sc1
    buffer_load_dwordx3 v[148:150], v7, s[16:19], s24 offen offset:128 sc1
    buffer_load_dwordx3 v[152:154], v7, s[16:19], s25 offen offset:0 sc1
    buffer_load_dwordx3 v[156:158], v7, s[16:19], s25 offen offset:128 sc1
    buffer_load_dwordx3 v[160:162], v7, s[16:19], s26 offen offset:0 sc1
    buffer_load_dwordx3 v[164:166], v7, s[16:19], s26 offen offset:128 sc1
    buffer_load_dwordx3 v[168:170], v7, s[16:19], s27 offen offset:0 sc1
    buffer_load_dwordx3 v[172:174], v7, s[16:19], s27 offen offset:128 sc1
    s_branch L_m_149chk
L_m_149poll:
    s_quadmask_b64 s[8:9], s[8:9]
    s_bitreplicate_b64_b32 s[8:9], s8
    s_wqm_b32 s8, s8
    s_bitreplicate_b64_b32 exec, s8
    buffer_load_dwordx3 v[144:146], v7, s[16:19], s24 offen offset:0 sc1
    s_quadmask_b64 s[10:11], s[10:11]
    s_bitreplicate_b64_b32 s[10:11], s10
    s_wqm_b32 s10, s10
    s_bitreplicate_b64_b32 exec, s10
    buffer_load_dwordx3 v[148:150], v7, s[16:19], s24 offen offset:128 sc1
    s_quadmask_b64 s[12:13], s[12:13]
    s_bitreplicate_b64_b32 s[12:13], s12
    s_wqm_b32 s12, s12
    s_bitreplicate_b64_b32 exec, s12
    buffer_load_dwordx3 v[152:154], v7, s[16:19], s25 offen offset:0 sc1
    s_quadmask_b64 s[14:15], s[14:15]
    s_bitreplicate_b64_b32 s[14:15], s14
    s_wqm_b32 s14, s14
    s_bitreplicate_b64_b32 exec, s14
    buffer_load_dwordx3 v[156:158], v7, s[16:19], s25 offen offset:128 sc1
    s_quadmask_b64 s[42:43], s[42:43]
    s_bitreplicate_b64_b32 s[42:43], s42
    s_wqm_b32 s42, s42
    s_bitreplicate_b64_b32 exec, s42
    buffer_load_dwordx3 v[160:162], v7, s[16:19], s26 offen offset:0 sc1
    s_quadmask_b64 s[44:45], s[44:45]
    s_bitreplicate_b64_b32 s[44:45], s44
    s_wqm_b32 s44, s44
    s_bitreplicate_b64_b32 exec, s44
    buffer_load_dwordx3 v[164:166], v7, s[16:19], s26 offen offset:128 sc1
    s_quadmask_b64 s[46:47], s[46:47]
    s_bitreplicate_b64_b32 s[46:47], s46
    s_wqm_b32 s46, s46
    s_bitreplicate_b64_b32 exec, s46
    buffer_load_dwordx3 v[168:170], v7, s[16:19], s27 offen offset:0 sc1
    s_quadmask_b64 s[50:51], s[50:51]
    s_bitreplicate_b64_b32 s[50:51], s50
    s_wqm_b32 s50, s50
    s_bitreplicate_b64_b32 exec, s50
    buffer_load_dwordx3 v[172:174], v7, s[16:19], s27 offen offset:128 sc1
    s_mov_b64 exec, -1
    s_add_u32 s33, s33, 1
    s_cmp_lt_u32 s33, 400000
    s_cbranch_scc0 L_exit
L_m_149chk:
    s_waitcnt vmcnt(0)
    v_cmp_ne_u32_e64 s[8:9], s28, v144
    v_cmp_ne_u32_e64 s[10:11], s28, v148
    v_cmp_ne_u32_e64 s[12:13], s28, v152
    v_cmp_ne_u32_e64 s[14:15], s28, v156
    v_cmp_ne_u32_e64 s[42:43], s28, v160
    v_cmp_ne_u32_e64 s[44:45], s28, v164
    v_cmp_ne_u32_e64 s[46:47], s28, v168
    v_cmp_ne_u32_e64 s[50:51], s28, v172
    s_or_b64 vcc, s[8:9], s[10:11]
    s_or_b64 vcc, vcc, s[12:13]
    s_or_b64 vcc, vcc, s[14:15]
    s_or_b64 vcc, vcc, s[42:43]
    s_or_b64 vcc, vcc, s[44:45]
    s_or_b64 vcc, vcc, s[46:47]
    s_or_b64 vcc, vcc, s[50:51]
    s_cbranch_scc1 L_m_149poll
    v_lshlrev_b32 v52, 16, v145
    v_and_b32 v53, 0xffff0000, v145
    v_lshlrev_b32 v68, 16, v161
    v_and_b32 v69, 0xffff0000, v161
    v_lshlrev_b32 v54, 16, v146
    v_and_b32 v55, 0xffff0000, v146
    v_lshlrev_b32 v70, 16, v162
    v_and_b32 v71, 0xffff0000, v162
    v_lshlrev_b32 v56, 16, v149
    v_and_b32 v57, 0xffff0000, v149
    v_lshlrev_b32 v72, 16, v165
    v_and_b32 v73, 0xffff0000, v165
    v_lshlrev_b32 v58, 16, v150
    v_and_b32 v59, 0xffff0000, v150
    v_lshlrev_b32 v74, 16, v166
    v_and_b32 v75, 0xffff0000, v166
    v_lshlrev_b32 v60, 16, v153
    v_and_b32 v61, 0xffff0000, v153
    v_lshlrev_b32 v76, 16, v169
    v_and_b32 v77, 0xffff0000, v169
    v_lshlrev_b32 v62, 16, v154
    v_and_b32 v63, 0xffff0000, v154
    v_lshlrev_b32 v78, 16, v170
    v_and_b32 v79, 0xffff0000, v170
    v_lshlrev_b32 v64, 16, v157
    v_and_b32 v65, 0xffff0000, v157
    v_lshlrev_b32 v80, 16, v173
    v_and_b32 v81, 0xffff0000, v173
    v_lshlrev_b32 v66, 16, v158
    v_and_b32 v67, 0xffff0000, v158
    v_lshlrev_b32 v82, 16, v174
    v_and_b32 v83, 0xffff0000, v174
    v_add_f32 v68, 1.0, v68
    v_add_f32 v69, 1.0, v69
    v_add_f32 v70, 1.0, v70
    v_add_f32 v71, 1.0, v71
    v_add_f32 v72, 1.0, v72
    v_add_f32 v73, 1.0, v73
    v_add_f32 v74, 1.0, v74
    v_add_f32 v75, 1.0, v75
    v_add_f32 v76, 1.0, v76
    v_add_f32 v77, 1.0, v77
    v_add_f32 v78, 1.0, v78
    v_add_f32 v79, 1.0, v79
    v_add_f32 v80, 1.0, v80
    v_add_f32 v81, 1.0, v81
    v_add_f32 v82, 1.0, v82
    v_add_f32 v83, 1.0, v83
    v_cvt_pk_bf16_f32 v68, 0, v68
    v_cvt_pk_bf16_f32 v69, 0, v69
    v_cvt_pk_bf16_f32 v70, 0, v70
    v_cvt_pk_bf16_f32 v71, 0, v71
    v_cvt_pk_bf16_f32 v72, 0, v72
    v_cvt_pk_bf16_f32 v73, 0, v73
    v_cvt_pk_bf16_f32 v74, 0, v74
    v_cvt_pk_bf16_f32 v75, 0, v75
    v_cvt_pk_bf16_f32 v76, 0, v76
    v_cvt_pk_bf16_f32 v77, 0, v77
    v_cvt_pk_bf16_f32 v78, 0, v78
    v_cvt_pk_bf16_f32 v79, 0, v79
    v_cvt_pk_bf16_f32 v80, 0, v80
    v_cvt_pk_bf16_f32 v81, 0, v81
    v_cvt_pk_bf16_f32 v82, 0, v82
    v_cvt_pk_bf16_f32 v83, 0, v83
    s_lshl_b32 s30, s29, 12
    s_add_u32 s30, s30, 146432
    v_add_u32 v12, s30, v5
    ds_write_b128 v12, v[60:63] offset:0
    ds_write_b128 v12, v[64:67] offset:1024
    ds_write_b128 v12, v[76:79] offset:2048
    ds_write_b128 v12, v[80:83] offset:3072
L_nofp:
    s_cmp_eq_u32 s29, 1
    s_cbranch_scc0 L_nosm
    s_lshl_b32 s26, s5, 3
    s_or_b32 s26, s26, s4
    s_lshl_b32 s26, s26, 9
    s_add_u32 s26, s26, 262144
    s_lshl_b32 s27, s6, 7
    s_add_u32 s27, s27, s26
    v_lshrrev_b32 v13, 4, v0
    v_mov_b32 v49, v4
    v_and_b32 v50, 15, v0
    v_lshlrev_b32 v50, 4, v50
    v_lshl_or_b32 v50, v13, 9, v50
    s_mov_b32 s32, 0x3db8aa3b
L_spin_150:
    v_mov_b32 v12, 0
    ds_read_b32 v12, v12 offset:16
    s_waitcnt lgkmcnt(0)
    v_readfirstlane_b32 s31, v12
    s_cmp_ge_u32 s31, 1
    s_cbranch_scc1 L_got_151
    s_add_u32 s33, s33, 1
    s_cmp_lt_u32 s33, 400000
    s_cbranch_scc1 L_spin_150
    s_branch L_exit
L_got_151:
    s_lshl_b32 s30, s4, 8
    s_add_u32 s30, s30, 327680
    v_and_b32 v48, 31, v0
    v_lshlrev_b32 v48, 2, v48
    buffer_load_dword v48, v48, s[16:19], s30 offen sc1
L_spin_152:
    v_mov_b32 v12, 0
    ds_read_b32 v12, v12 offset:20
    s_waitcnt lgkmcnt(0)
    v_readfirstlane_b32 s31, v12
    s_cmp_ge_u32 s31, 4
    s_cbranch_scc1 L_got_153
    s_add_u32 s33, s33, 1
    s_cmp_lt_u32 s33, 400000
    s_cbranch_scc1 L_spin_152
    s_branch L_exit
L_got_153:
L_spin_154:
    v_mov_b32 v12, 0
    ds_read_b32 v12, v12 offset:4
    s_waitcnt lgkmcnt(0)
    v_readfirstlane_b32 s31, v12
    s_cmp_ge_u32 s31, 4
    s_cbranch_scc1 L_got_155
    s_add_u32 s33, s33, 1
    s_cmp_lt_u32 s33, 400000
    s_cbranch_scc1 L_spin_154
    s_branch L_exit
L_got_155:
    s_waitcnt vmcnt(0)
    v_cmp_eq_u32 vcc, s71, v48
    s_bcnt1_i32_b32 s75, vcc_lo
    ds_read_b128 v[12:15], v5 offset:4096
    ds_read_b128 v[16:19], v5 offset:5120
    ds_read_b128 v[20:23], v5 offset:6144
    ds_read_b128 v[24:27], v5 offset:7168
    s_waitcnt lgkmcnt(0)
    v_cvt_pk_bf16_f32 v12, 0, v12
    v_cvt_pk_bf16_f32 v13, 0, v13
    v_cvt_pk_bf16_f32 v14, 0, v14
    v_cvt_pk_bf16_f32 v15, 0, v15
    v_cvt_pk_bf16_f32 v16, 0, v16
    v_cvt_pk_bf16_f32 v17, 0, v17
    v_cvt_pk_bf16_f32 v18, 0, v18
    v_cvt_pk_bf16_f32 v19, 0, v19
    v_cvt_pk_bf16_f32 v20, 0, v20
    v_cvt_pk_bf16_f32 v21, 0, v21
    v_cvt_pk_bf16_f32 v22, 0, v22
    v_cvt_pk_bf16_f32 v23, 0, v23
    v_cvt_pk_bf16_f32 v24, 0, v24
    v_cvt_pk_bf16_f32 v25, 0, v25
    v_cvt_pk_bf16_f32 v26, 0, v26
    v_cvt_pk_bf16_f32 v27, 0, v27
    v_max3_f32 v45, v12, v13, v14
    v_max3_f32 v45, v45, v15, v16
    v_max3_f32 v45, v45, v17, v18
    v_max3_f32 v45, v45, v19, v20
    v_max3_f32 v45, v45, v21, v22
    v_max3_f32 v45, v45, v23, v24
    v_max3_f32 v45, v45, v25, v26
    v_max_f32 v45, v45, v27
    s_nop 1
    v_max_f32_dpp v45, v45, v45 quad_perm:[1,0,3,2] row_mask:0xf bank_mask:0xf
    s_nop 1
    v_max_f32_dpp v45, v45, v45 quad_perm:[2,3,0,1] row_mask:0xf bank_mask:0xf
    s_nop 1
    v_max_f32_dpp v45, v45, v45 row_half_mirror row_mask:0xf bank_mask:0xf
    v_mov_b32 v47, v45
    s_nop 1
    v_permlane16_swap_b32 v45, v47
    v_max_f32 v45, v45, v47
    v_mov_b32 v47, v45
    s_nop 1
    v_permlane32_swap_b32 v45, v47
    v_max_f32 v45, v45, v47
    v_sub_f32 v28, v12, v45
    v_sub_f32 v29, v13, v45
    v_sub_f32 v30, v14, v45
    v_sub_f32 v31, v15, v45
    v_sub_f32 v32, v16, v45
    v_sub_f32 v33, v17, v45
    v_sub_f32 v34, v18, v45
    v_sub_f32 v35, v19, v45
    v_sub_f32 v36, v20, v45
    v_sub_f32 v37, v21, v45
    v_sub_f32 v38, v22, v45
    v_sub_f32 v39, v23, v45
    v_sub_f32 v40, v24, v45
    v_sub_f32 v41, v25, v45
    v_sub_f32 v42, v26, v45
    v_sub_f32 v43, v27, v45
    v_mul_f32 v28, s32, v28
    v_mul_f32 v29, s32, v29
    v_mul_f32 v30, s32, v30
    v_mul_f32 v31, s32, v31
    v_mul_f32 v32, s32, v32
    v_mul_f32 v33, s32, v33
    v_mul_f32 v34, s32, v34
    v_mul_f32 v35, s32, v35
    v_mul_f32 v36, s32, v36
    v_mul_f32 v37, s32, v37
    v_mul_f32 v38, s32, v38
    v_mul_f32 v39, s32, v39
    v_mul_f32 v40, s32, v40
    v_mul_f32 v41, s32, v41
    v_mul_f32 v42, s32, v42
    v_mul_f32 v43, s32, v43
    v_exp_f32 v28, v28
    v_exp_f32 v29, v29
    v_exp_f32 v30, v30
    v_exp_f32 v31, v31
    v_exp_f32 v32, v32
    v_exp_f32 v33, v33
    v_exp_f32 v34, v34
    v_exp_f32 v35, v35
    v_exp_f32 v36, v36
    v_exp_f32 v37, v37
    v_exp_f32 v38, v38
    v_exp_f32 v39, v39
    v_exp_f32 v40, v40
    v_exp_f32 v41, v41
    v_exp_f32 v42, v42
    v_exp_f32 v43, v43
    v_pk_add_f32 v[28:29], v[28:29], v[36:37]
    v_pk_add_f32 v[30:31], v[30:31], v[38:39]
    v_pk_add_f32 v[32:33], v[32:33], v[40:41]
    v_pk_add_f32 v[34:35], v[34:35], v[42:43]
    v_pk_add_f32 v[28:29], v[28:29], v[32:33]
    v_pk_add_f32 v[30:31], v[30:31], v[34:35]
    v_pk_add_f32 v[28:29], v[28:29], v[30:31]
    v_add_f32 v46, v28, v29
    s_nop 1
    v_add_f32_dpp v46, v46, v46 quad_perm:[1,0,3,2] row_mask:0xf bank_mask:0xf
    s_nop 1
    v_add_f32_dpp v46, v46, v46 quad_perm:[2,3,0,1] row_mask:0xf bank_mask:0xf
    s_nop 1
    v_add_f32_dpp v46, v46, v46 row_half_mirror row_mask:0xf bank_mask:0xf
    v_mov_b32 v47, v46
    s_nop 1
    v_permlane16_swap_b32 v46, v47
    v_add_f32 v46, v46, v47
    v_mov_b32 v47, v46
    s_nop 1
    v_permlane32_swap_b32 v46, v47
    v_add_f32 v46, v46, v47
    s_and_b32 s30, s28, 0xffff
    s_lshr_b32 s31, s28, 16
    v_or_b32 v28, s30, v45
    v_mov_b32 v29, v46
    v_mov_b32 v30, s31
    v_mov_b32_dpp v31, v46 row_ror:8 row_mask:0xf bank_mask:0xf
    v_or_b32_dpp v30, v45, v30 row_ror:8 row_mask:0xf bank_mask:0xf
    s_mov_b64 exec, 0xff
    s_cmp_eq_u32 s75, 32
    s_cbranch_scc0 L_st_156
    buffer_store_dwordx4 v[28:31], v5, s[16:19], s27 offen
    s_branch L_std_157
L_st_156:
    buffer_store_dwordx4 v[28:31], v5, s[16:19], s27 offen sc1
L_std_157:
    s_mov_b64 exec, -1
    s_mov_b32 s30, 0x05040100
    v_mov_b32_dpp v32, v28 row_newbcast:0 row_mask:0xf bank_mask:0xf
    v_mov_b32_dpp v33, v29 row_newbcast:0 row_mask:0xf bank_mask:0xf
    v_mov_b32_dpp v34, v30 row_newbcast:0 row_mask:0xf bank_mask:0xf
    v_mov_b32_dpp v35, v31 row_newbcast:0 row_mask:0xf bank_mask:0xf
    s_lshl_b32 s31, s6, 4
    s_lshl_b64 s[8:9], 0xffff, s31
    s_not_b64 s[8:9], s[8:9]
L_mlpoll:
    s_mov_b64 exec, s[8:9]
    buffer_load_dwordx4 v[32:35], v49, s[16:19], s26 offen sc1
    s_mov_b64 exec, -1
    s_waitcnt vmcnt(0)
    v_perm_b32 v36, v34, v32, s30
    v_cmp_ne_u32 vcc, s28, v36
    s_cbranch_vccz L_mlgot
    s_add_u32 s33, s33, 1
    s_cmp_lt_u32 s33, 400000
    s_cbranch_scc1 L_mlpoll
    s_branch L_exit
L_mlgot:
    v_cndmask_b32 v29, v34, v32, s[36:37]
    v_cndmask_b32 v30, v35, v33, s[36:37]
    v_and_b32 v29, 0xffff0000, v29
    v_mov_b32 v45, v29
    v_mov_b32 v47, v45
    s_nop 1
    v_permlane16_swap_b32 v45, v47
    v_max_f32 v45, v45, v47
    v_mov_b32 v47, v45
    s_nop 1
    v_permlane32_swap_b32 v45, v47
    v_max_f32 v45, v45, v47
    v_sub_f32 v29, v29, v45
    v_mul_f32 v29, s32, v29
    v_exp_f32 v29, v29
    s_nop 0
    v_mul_f32 v46, v29, v30
    v_mov_b32 v47, v46
    s_nop 1
    v_permlane16_swap_b32 v46, v47
    v_add_f32 v46, v46, v47
    v_mov_b32 v47, v46
    s_nop 1
    v_permlane32_swap_b32 v46, v47
    v_add_f32 v46, v46, v47
    v_rcp_f32 v46, v46
    v_sub_f32 v28, v12, v45
    v_sub_f32 v29, v13, v45
    v_sub_f32 v30, v14, v45
    v_sub_f32 v31, v15, v45
    v_sub_f32 v32, v16, v45
    v_sub_f32 v33, v17, v45
    v_sub_f32 v34, v18, v45
    v_sub_f32 v35, v19, v45
    v_sub_f32 v36, v20, v45
    v_sub_f32 v37, v21, v45
    v_sub_f32 v38, v22, v45
    v_sub_f32 v39, v23, v45
    v_sub_f32 v40, v24, v45
    v_sub_f32 v41, v25, v45
    v_sub_f32 v42, v26, v45
    v_sub_f32 v43, v27, v45
    v_mul_f32 v28, s32, v28
    v_mul_f32 v29, s32, v29
    v_mul_f32 v30, s32, v30
    v_mul_f32 v31, s32, v31
    v_mul_f32 v32, s32, v32
    v_mul_f32 v33, s32, v33
    v_mul_f32 v34, s32, v34
    v_mul_f32 v35, s32, v35
    v_mul_f32 v36, s32, v36
    v_mul_f32 v37, s32, v37
    v_mul_f32 v38, s32, v38
    v_mul_f32 v39, s32, v39
    v_mul_f32 v40, s32, v40
    v_mul_f32 v41, s32, v41
    v_mul_f32 v42, s32, v42
    v_mul_f32 v43, s32, v43
    v_exp_f32 v28, v28
    v_exp_f32 v29, v29
    v_exp_f32 v30, v30
    v_exp_f32 v31, v31
    v_exp_f32 v32, v32
    v_exp_f32 v33, v33
    v_exp_f32 v34, v34
    v_exp_f32 v35, v35
    v_exp_f32 v36, v36
    v_exp_f32 v37, v37
    v_exp_f32 v38, v38
    v_exp_f32 v39, v39
    v_exp_f32 v40, v40
    v_exp_f32 v41, v41
    v_exp_f32 v42, v42
    v_exp_f32 v43, v43
    v_pk_mul_f32 v[28:29], v[28:29], v[46:47] op_sel_hi:[1,0]
    v_pk_mul_f32 v[30:31], v[30:31], v[46:47] op_sel_hi:[1,0]
    v_pk_mul_f32 v[32:33], v[32:33], v[46:47] op_sel_hi:[1,0]
    v_pk_mul_f32 v[34:35], v[34:35], v[46:47] op_sel_hi:[1,0]
    v_pk_mul_f32 v[36:37], v[36:37], v[46:47] op_sel_hi:[1,0]
    v_pk_mul_f32 v[38:39], v[38:39], v[46:47] op_sel_hi:[1,0]
    v_pk_mul_f32 v[40:41], v[40:41], v[46:47] op_sel_hi:[1,0]
    v_pk_mul_f32 v[42:43], v[42:43], v[46:47] op_sel_hi:[1,0]
    v_cvt_pk_bf16_f32 v12, v28, v32
    v_cvt_pk_bf16_f32 v13, v36, v40
    v_cvt_pk_bf16_f32 v14, v29, v33
    v_cvt_pk_bf16_f32 v15, v37, v41
    v_cvt_pk_bf16_f32 v16, v30, v34
    v_cvt_pk_bf16_f32 v17, v38, v42
    v_cvt_pk_bf16_f32 v18, v31, v35
    v_cvt_pk_bf16_f32 v19, v39, v43
    ds_write_b128 v50, v[12:15] offset:2048
    ds_write_b128 v50, v[16:19] offset:2304
    s_add_u32 s30, s75, 1
    v_mov_b32 v20, s30
    v_mov_b32 v21, s28
    v_mov_b32 v22, 0
    s_waitcnt lgkmcnt(0)
    ds_write_b64 v22, v[20:21] offset:8
L_nosm:
    v_and_b32 v11, 3, v0
    v_mul_u32_u24 v11, 7, v11
    v_lshrrev_b32 v11, v11, s28
    v_and_b32 v11, 0xff, v11
    v_bfi_b32 v11, 1, s28, v11
    s_cmp_eq_u32 s74, 3
    s_cbranch_scc1 L_ffn
    s_cmp_eq_u32 s5, 7
    s_cbranch_scc1 L_idle
    s_lshl1_add_u32 s39, s7, s29
    s_add_u32 s39, s39, 6
    s_cmp_ge_u32 s39, 56
    s_cselect_b32 s30, 56, 0
    s_sub_u32 s39, s39, s30
    v_and_b32 v86, 0xff, v4
    v_and_b32 v12, 7, v0
    v_mul_u32_u24 v12, 896, v12
    v_and_b32 v13, 16, v0
    v_lshrrev_b32 v13, 1, v13
    s_lshl_b32 s27, s39, 4
    v_add3_u32 v85, s27, v12, v13
    s_cmp_ge_u32 s29, 2
    s_cbranch_scc0 L_noz
L_spin_158:
    v_mov_b32 v12, 0
    ds_read_b32 v12, v12 offset:0
    s_waitcnt lgkmcnt(0)
    v_readfirstlane_b32 s31, v12
    s_cmp_ge_u32 s31, 1
    s_cbranch_scc1 L_got_159
    s_add_u32 s33, s33, 1
    s_cmp_lt_u32 s33, 400000
    s_cbranch_scc1 L_spin_158
    s_branch L_exit
L_got_159:
    s_mov_b64 s[20:21], s[40:41]
    s_cmp_eq_u32 s4, 0
    s_cselect_b32 s31, 43008, 0
    s_lshl_b32 s30, s39, 8
    s_add_u32 s30, s30, s31
    s_add_u32 s30, s30, 32768
    buffer_load_dwordx2 v[20:21], v85, s[20:23], 0 offen
L_zpoll:
    buffer_load_dwordx3 v[16:18], v86, s[16:19], s30 offen sc1
    s_waitcnt vmcnt(0)
    v_cmp_ne_u32 vcc, s28, v16
    s_cbranch_vccz L_zgot
    s_add_u32 s33, s33, 1
    s_cmp_lt_u32 s33, 400000
    s_cbranch_scc1 L_zpoll
    s_branch L_exit
L_zgot:
    v_lshlrev_b32 v80, 16, v17
    v_and_b32 v81, 0xffff0000, v17
    v_lshlrev_b32 v82, 16, v18
    v_and_b32 v83, 0xffff0000, v18
    v_lshlrev_b32 v72, 16, v20
    v_and_b32 v73, 0xffff0000, v20
    v_lshlrev_b32 v74, 16, v21
    v_and_b32 v75, 0xffff0000, v21
L_noz:
    v_and_b32 v13, 40, v0
    v_lshl_or_b32 v85, v13, 24, v85
    v_lshl_or_b32 v84, v13, 24, v86
    v_lshrrev_b32 v13, 5, v0
    v_add_u32 v14, 1572864, v5
    s_sub_u32 s30, s4, 0
    v_cmp_eq_u32 vcc, s30, v13
    s_nop 1
    v_cndmask_b32 v52, v5, v14, vcc
    s_sub_u32 s30, s4, 2
    v_cmp_eq_u32 vcc, s30, v13
    s_nop 1
    v_cndmask_b32 v53, v5, v14, vcc
    s_sub_u32 s30, s4, 4
    v_cmp_eq_u32 vcc, s30, v13
    s_nop 1
    v_cndmask_b32 v54, v5, v14, vcc
    s_sub_u32 s30, s4, 6
    v_cmp_eq_u32 vcc, s30, v13
    s_nop 1
    v_cndmask_b32 v55, v5, v14, vcc
    s_lshl_b32 s68, s39, 12
    s_add_u32 s69, s68, 1572864
    s_add_u32 s68, s68, 1048576
    s_lshl_b32 s32, s4, 6
    s_add_u32 s32, s32, s39
    s_lshl_b32 s32, s32, 8
    s_add_u32 s32, s32, 393216
    v_and_b32 v13, 1, v0
    v_lshlrev_b32 v13, 4, v13
    v_mov_b32 v14, 0x3f80
    v_lshlrev_b32 v14, v13, v14
    v_bfe_u32 v13, v0, 1, 2
    v_cmp_eq_u32 vcc, 0, v13
    s_nop 1
    v_cndmask_b32 v76, 0, v14, vcc
    v_cmp_eq_u32 vcc, 1, v13
    s_nop 1
    v_cndmask_b32 v77, 0, v14, vcc
    v_cmp_eq_u32 vcc, 2, v13
    s_nop 1
    v_cndmask_b32 v78, 0, v14, vcc
    v_cmp_eq_u32 vcc, 3, v13
    s_nop 1
    v_cndmask_b32 v79, 0, v14, vcc
    v_and_b32 v13, 7, v0
    v_mul_u32_u24 v13, 3, v13
    v_lshrrev_b32 v13, v13, s28
    s_mov_b32 s38, 0x10001
    s_and_b32 s30, s28, 1
    v_bfe_u32 v36, v13, 1, 1
    v_lshl_or_b32 v36, v36, 16, s30
    v_bfe_u32 v37, v13, 2, 1
    v_bfe_u32 v13, v13, 3, 1
    v_lshl_or_b32 v37, v13, 16, v37
    v_mov_b32 v43, v36
    s_nop 0
    v_mov_b32_dpp v43, v37 quad_perm:[0,1,2,3] row_mask:0xa bank_mask:0xf
    s_lshl_b32 s24, s34, 14
    s_lshl_b32 s30, s29, 7
    s_add_u32 s24, s24, s30
    s_add_u32 s24, s24, 524288
    s_add_u32 s25, s24, 4096
    s_add_u32 s26, s24, 8192
    s_add_u32 s27, s24, 12288
    v_and_b32 v12, 7, v0
    v_lshrrev_b32 v13, 3, v0
    v_lshlrev_b32 v14, 4, v12
    v_lshl_or_b32 v40, v13, 9, v14
    v_add_u32 v15, v12, v13
    v_and_b32 v15, 7, v15
    v_lshlrev_b32 v15, 4, v15
    v_lshl_or_b32 v41, v12, 7, v15
    v_lshrrev_b32 v16, 4, v0
    v_add_u32 v15, v12, v16
    v_and_b32 v15, 7, v15
    v_lshlrev_b32 v15, 4, v15
    v_lshl_or_b32 v44, v16, 7, v15
    v_xor_b32 v45, 64, v44
    s_lshr_b32 s30, s29, 1
    s_lshl_b32 s30, s30, 10
    s_and_b32 s31, s29, 1
    s_lshl3_add_u32 s30, s31, s30
    v_add_u32 v41, s30, v41
    v_and_b32 v13, 24, v0
    v_lshl_or_b32 v14, v13, 25, v14
    v_lshrrev_b32 v13, 5, v0
    v_lshl_or_b32 v42, v13, 12, v14
    s_lshl2_add_u32 s73, s5, s29
    s_lshl_b32 s73, s73, 6
    s_add_u32 s73, s73, s34
    s_lshl_b32 s73, s73, 7
    s_add_u32 s70, s73, 2621440
    s_add_u32 s73, s73, 1048576
    s_mov_b32 s20, s62
    s_mov_b32 s21, s63
    s_mov_b32 s22, 7168
    s_mov_b32 s23, 0x20000
L_spin_160:
    v_mov_b32 v12, 0
    ds_read_b32 v12, v12 offset:8
    s_waitcnt lgkmcnt(0)
    v_readfirstlane_b32 s31, v12
    s_cmp_ge_u32 s31, 1
    s_cbranch_scc1 L_got_161
    s_add_u32 s33, s33, 1
    s_cmp_lt_u32 s33, 400000
    s_cbranch_scc1 L_spin_160
    s_branch L_exit
L_got_161:
    s_sub_u32 s75, s31, 1
    s_mov_b64 s[44:45], s[66:67]
    s_mov_b64 s[56:57], s[66:67]
    s_mov_b32 s47, 0x20000
    s_mov_b32 s59, 0x20000
    s_cmp_eq_u32 s75, 32
    s_cselect_b32 s46, s18, 0
    s_cselect_b32 s58, 0, s18
    s_movk_i32 s60, 0xff
    s_movk_i32 s61, 0xff
    s_mov_b64 s[48:49], s[66:67]
    s_mov_b32 s51, 0x20000
    s_cmp_eq_u32 s4, 1
    s_cselect_b32 s50, s18, 0
    s_sub_u32 s72, s32, 0x4000
    s_barrier
    buffer_load_dwordx4 v[12:15], v40, s[16:19], s24 offen sc1
    buffer_load_dwordx4 v[16:19], v40, s[16:19], s25 offen sc1
    buffer_load_dwordx4 v[20:23], v40, s[16:19], s26 offen sc1
    buffer_load_dwordx4 v[24:27], v40, s[16:19], s27 offen sc1
    ds_read_b64_tr_b16 v[88:89], v3 offset:0
    ds_read_b64_tr_b16 v[90:91], v3 offset:128
    ds_read_b64_tr_b16 v[92:93], v3 offset:4608
    ds_read_b64_tr_b16 v[94:95], v3 offset:4736
    ds_read_b64_tr_b16 v[96:97], v3 offset:9216
    ds_read_b64_tr_b16 v[98:99], v3 offset:9344
    ds_read_b64_tr_b16 v[100:101], v3 offset:13824
    ds_read_b64_tr_b16 v[102:103], v3 offset:13952
    s_mov_b64 s[40:41], -1
    s_mov_b64 s[42:43], -1
    s_mov_b64 s[52:53], -1
    s_mov_b64 s[54:55], -1
    s_branch L_wchk
L_wpoll:
    s_mov_b64 exec, s[40:41]
    buffer_load_dwordx4 v[12:15], v40, s[16:19], s24 offen sc1
    s_mov_b64 exec, s[42:43]
    buffer_load_dwordx4 v[16:19], v40, s[16:19], s25 offen sc1
    s_mov_b64 exec, s[52:53]
    buffer_load_dwordx4 v[20:23], v40, s[16:19], s26 offen sc1
    s_mov_b64 exec, s[54:55]
    buffer_load_dwordx4 v[24:27], v40, s[16:19], s27 offen sc1
    s_quadmask_b64 s[8:9], s[8:9]
    s_bitreplicate_b64_b32 s[8:9], s8
    s_wqm_b32 s8, s8
    s_bitreplicate_b64_b32 s[40:41], s8
    s_quadmask_b64 s[10:11], s[10:11]
    s_bitreplicate_b64_b32 s[10:11], s10
    s_wqm_b32 s10, s10
    s_bitreplicate_b64_b32 s[42:43], s10
    s_quadmask_b64 s[12:13], s[12:13]
    s_bitreplicate_b64_b32 s[12:13], s12
    s_wqm_b32 s12, s12
    s_bitreplicate_b64_b32 s[52:53], s12
    s_quadmask_b64 s[14:15], s[14:15]
    s_bitreplicate_b64_b32 s[14:15], s14
    s_wqm_b32 s14, s14
    s_bitreplicate_b64_b32 s[54:55], s14
    s_mov_b64 exec, -1
    s_add_u32 s33, s33, 1
    s_cmp_lt_u32 s33, 400000
    s_cbranch_scc0 L_exit
L_wchk:
    s_waitcnt vmcnt(0)
    v_cmp_ne_u32_sdwa s[8:9], v12, v11 src0_sel:BYTE_0 src1_sel:DWORD
    v_cmp_ne_u32_sdwa s[10:11], v16, v11 src0_sel:BYTE_0 src1_sel:DWORD
    v_cmp_ne_u32_sdwa s[12:13], v20, v11 src0_sel:BYTE_0 src1_sel:DWORD
    v_cmp_ne_u32_sdwa s[14:15], v24, v11 src0_sel:BYTE_0 src1_sel:DWORD
    s_or_b64 vcc, s[8:9], s[10:11]
    s_or_b64 vcc, vcc, s[12:13]
    s_or_b64 vcc, vcc, s[14:15]
    s_cbranch_scc1 L_wpoll
    v_xor_b32 v12, v11, v12
    v_xor_b32 v16, v11, v16
    v_xor_b32 v20, v11, v20
    v_xor_b32 v24, v11, v24
    v_pk_add_f32 v[14:15], v[14:15], v[18:19]
    v_pk_add_f32 v[22:23], v[22:23], v[26:27]
    v_pk_add_f32 v[12:13], v[12:13], v[16:17]
    v_pk_add_f32 v[20:21], v[20:21], v[24:25]
    v_pk_add_f32 v[14:15], v[14:15], v[22:23]
    v_pk_add_f32 v[12:13], v[12:13], v[20:21]
    v_cvt_pk_bf16_f32 v12, v12, v13
    v_cvt_pk_bf16_f32 v13, v14, v15
    ds_write_b64 v41, v[12:13] offset:8192
    s_waitcnt lgkmcnt(0)
    s_barrier
    ds_read_b128 v[12:15], v44 offset:8192
    ds_read_b128 v[16:19], v45 offset:8704
    ds_read_b128 v[20:23], v44 offset:9216
    ds_read_b128 v[24:27], v45 offset:9728
    s_waitcnt lgkmcnt(3)
    v_mfma_f32_16x16x32_bf16 v[28:31], v[88:91], v[12:15], 0
    s_waitcnt lgkmcnt(2)
    v_mfma_f32_16x16x32_bf16 v[28:31], v[92:95], v[16:19], v[28:31]
    s_waitcnt lgkmcnt(1)
    v_mfma_f32_16x16x32_bf16 v[28:31], v[96:99], v[20:23], v[28:31]
    s_waitcnt lgkmcnt(0)
    v_mfma_f32_16x16x32_bf16 v[28:31], v[100:103], v[24:27], v[28:31]
    s_cmp_eq_u32 s4, 0
    s_nop 6
    v_add_u32 v28, 0x8000, v28
    v_add_u32 v29, 0x8000, v29
    v_add_u32 v30, 0x8000, v30
    v_add_u32 v31, 0x8000, v31
    v_cvt_pk_bf16_f32 v49, v30, v31
    v_cvt_pk_bf16_f32 v48, v28, v29
    v_bfi_b32 v49, s38, v43, v49
    v_bfi_b32 v48, s38, v43, v48
    s_nop 0
    v_permlane16_swap_b32 v49, v51
    v_permlane16_swap_b32 v48, v50
    s_mov_b64 exec, s[60:61]
    buffer_store_dwordx4 v[48:51], v42, s[16:19], s73 offen sc1
    s_cbranch_scc1 L_fin
    s_cmp_ge_u32 s29, 2
    buffer_store_dwordx4 v[48:51], v42, s[44:47], s70 offen
    buffer_store_dwordx4 v[48:51], v42, s[56:59], s70 offen sc1
    s_mov_b64 exec, -1
    s_cbranch_scc0 L_exit
    buffer_load_dwordx4 v[56:59], v52, s[16:19], s68 offen offset:0 sc1
    buffer_load_dwordx4 v[60:63], v53, s[16:19], s68 offen offset:1024 sc1
    buffer_load_dwordx4 v[64:67], v54, s[16:19], s68 offen offset:2048 sc1
    buffer_load_dwordx4 v[68:71], v55, s[16:19], s68 offen offset:3072 sc1
    s_mov_b64 s[40:41], -1
    s_mov_b64 s[42:43], -1
    s_mov_b64 s[52:53], -1
    s_mov_b64 s[54:55], -1
    s_branch L_achk
L_apoll:
    s_mov_b64 exec, s[40:41]
    buffer_load_dwordx4 v[56:59], v52, s[16:19], s68 offen offset:0 sc1
    s_mov_b64 exec, s[42:43]
    buffer_load_dwordx4 v[60:63], v53, s[16:19], s68 offen offset:1024 sc1
    s_mov_b64 exec, s[52:53]
    buffer_load_dwordx4 v[64:67], v54, s[16:19], s68 offen offset:2048 sc1
    s_mov_b64 exec, s[54:55]
    buffer_load_dwordx4 v[68:71], v55, s[16:19], s68 offen offset:3072 sc1
    s_mov_b64 exec, -1
    v_bitop3_b32 v32, v12, v13, s38 bitop3:0xa8
    v_cmp_ne_u32_e64 s[8:9], 0, v32
    v_bitop3_b32 v32, v14, v15, s38 bitop3:0xa8
    v_cmp_ne_u32_e64 s[10:11], 0, v32
    v_bitop3_b32 v32, v16, v17, s38 bitop3:0xa8
    v_cmp_ne_u32_e64 s[12:13], 0, v32
    v_bitop3_b32 v32, v18, v19, s38 bitop3:0xa8
    v_cmp_ne_u32_e64 s[14:15], 0, v32
    s_quadmask_b64 s[8:9], s[8:9]
    s_bitreplicate_b64_b32 s[8:9], s8
    s_wqm_b32 s8, s8
    s_bitreplicate_b64_b32 s[40:41], s8
    s_quadmask_b64 s[10:11], s[10:11]
    s_bitreplicate_b64_b32 s[10:11], s10
    s_wqm_b32 s10, s10
    s_bitreplicate_b64_b32 s[42:43], s10
    s_quadmask_b64 s[12:13], s[12:13]
    s_bitreplicate_b64_b32 s[12:13], s12
    s_wqm_b32 s12, s12
    s_bitreplicate_b64_b32 s[52:53], s12
    s_quadmask_b64 s[14:15], s[14:15]
    s_bitreplicate_b64_b32 s[14:15], s14
    s_wqm_b32 s14, s14
    s_bitreplicate_b64_b32 s[54:55], s14
    s_mov_b64 exec, -1
    s_add_u32 s33, s33, 1
    s_cmp_lt_u32 s33, 400000
    s_cbranch_scc0 L_exit
L_achk:
    s_waitcnt vmcnt(0)
    v_bitop3_b32 v12, v56, v57, v36 bitop3:0x7e
    v_bitop3_b32 v13, v58, v59, v37 bitop3:0x7e
    v_bitop3_b32 v14, v60, v61, v36 bitop3:0x7e
    v_bitop3_b32 v15, v62, v63, v37 bitop3:0x7e
    v_bitop3_b32 v16, v64, v65, v36 bitop3:0x7e
    v_bitop3_b32 v17, v66, v67, v37 bitop3:0x7e
    v_bitop3_b32 v18, v68, v69, v36 bitop3:0x7e
    v_bitop3_b32 v19, v70, v71, v37 bitop3:0x7e
    v_or3_b32 v32, v12, v13, v14
    v_or3_b32 v33, v15, v16, v17
    v_or3_b32 v32, v32, v18, v19
    v_bitop3_b32 v32, v32, v33, s38 bitop3:0xa8
    v_cmp_ne_u32 vcc, 0, v32
    s_cbranch_vccnz L_apoll
    v_xor_b32 v56, v36, v56
    v_xor_b32 v57, v36, v57
    v_xor_b32 v58, v37, v58
    v_xor_b32 v59, v37, v59
    v_xor_b32 v60, v36, v60
    v_xor_b32 v61, v36, v61
    v_mfma_f32_16x16x32_bf16 v[28:31], v[76:79], v[56:59], 0
    v_xor_b32 v62, v37, v62
    v_xor_b32 v63, v37, v63
    v_xor_b32 v64, v36, v64
    v_xor_b32 v65, v36, v65
    v_mfma_f32_16x16x32_bf16 v[28:31], v[76:79], v[60:63], v[28:31]
    v_xor_b32 v66, v37, v66
    v_xor_b32 v67, v37, v67
    v_xor_b32 v68, v36, v68
    v_xor_b32 v69, v36, v69
    v_mfma_f32_16x16x32_bf16 v[28:31], v[76:79], v[64:67], v[28:31]
    v_xor_b32 v70, v37, v70
    v_xor_b32 v71, v37, v71
    s_nop 1
    v_mfma_f32_16x16x32_bf16 v[28:31], v[76:79], v[68:71], v[28:31]
    s_nop 7
    v_add_f32_dpp v28, v28, v28 row_ror:8 row_mask:0xf bank_mask:0xf
    v_add_f32_dpp v29, v29, v29 row_ror:8 row_mask:0xf bank_mask:0xf
    v_add_f32_dpp v30, v30, v30 row_ror:8 row_mask:0xf bank_mask:0xf
    v_add_f32_dpp v31, v31, v31 row_ror:8 row_mask:0xf bank_mask:0xf
    v_pk_fma_f32 v[28:29], v[28:29], v[80:81], v[72:73]
    v_pk_fma_f32 v[30:31], v[30:31], v[82:83], v[74:75]
    v_cvt_pk_bf16_f32 v28, 0, v28
    v_cvt_pk_bf16_f32 v29, 0, v29
    v_or_b32 v28, v11, v28
    v_cvt_pk_bf16_f32 v30, 0, v30
    v_cvt_pk_bf16_f32 v31, 0, v31
    s_mov_b64 exec, 0xff00ff
    buffer_store_dwordx4 v[28:31], v84, s[44:47], s32 offen
    buffer_store_dwordx4 v[28:31], v84, s[56:59], s32 offen sc1
    buffer_store_dwordx4 v[28:31], v84, s[48:51], s72 offen sc1
    s_endpgm
L_fin:
    s_mov_b64 exec, -1
    s_cmp_ge_u32 s29, 2
    s_cbranch_scc0 L_exit
    v_mov_b32 v68, v36
    v_mov_b32 v69, v36
    v_mov_b32 v70, v37
    v_mov_b32 v71, v37
    buffer_load_dwordx4 v[56:59], v5, s[16:19], s69 offen offset:0 sc1
    buffer_load_dwordx4 v[60:63], v5, s[16:19], s69 offen offset:1024 sc1
    buffer_load_dwordx4 v[64:67], v5, s[16:19], s69 offen offset:2048 sc1
    s_mov_b32 exec_hi, 0
    buffer_load_dwordx4 v[68:71], v5, s[16:19], s69 offen offset:3072 sc1
    s_mov_b32 exec_hi, -1
L_ypoll:
    buffer_load_dwordx4 v[72:75], v86, s[16:19], s32 offen sc1
    s_waitcnt vmcnt(0)
    v_cmp_ne_u32_sdwa vcc, v72, v11 src0_sel:BYTE_0 src1_sel:DWORD
    s_cbranch_vccz L_ygot
    s_add_u32 s33, s33, 1
    s_cmp_lt_u32 s33, 400000
    s_cbranch_scc1 L_ypoll
    s_branch L_exit
L_ygot:
    v_xor_b32 v72, v11, v72
    s_mov_b64 s[40:41], -1
    s_mov_b64 s[42:43], -1
    s_mov_b64 s[52:53], -1
    s_mov_b64 s[54:55], -1
    s_mov_b32 s55, 0
    s_branch L_fchk
L_fpoll:
    s_mov_b64 exec, s[40:41]
    buffer_load_dwordx4 v[56:59], v5, s[16:19], s69 offen offset:0 sc1
    s_mov_b64 exec, s[42:43]
    buffer_load_dwordx4 v[60:63], v5, s[16:19], s69 offen offset:1024 sc1
    s_mov_b64 exec, s[52:53]
    buffer_load_dwordx4 v[64:67], v5, s[16:19], s69 offen offset:2048 sc1
    s_mov_b64 exec, s[54:55]
    buffer_load_dwordx4 v[68:71], v5, s[16:19], s69 offen offset:3072 sc1
    s_mov_b64 exec, -1
    v_bitop3_b32 v32, v12, v13, s38 bitop3:0xa8
    v_cmp_ne_u32_e64 s[8:9], 0, v32
    v_bitop3_b32 v32, v14, v15, s38 bitop3:0xa8
    v_cmp_ne_u32_e64 s[10:11], 0, v32
    v_bitop3_b32 v32, v16, v17, s38 bitop3:0xa8
    v_cmp_ne_u32_e64 s[12:13], 0, v32
    v_bitop3_b32 v32, v18, v19, s38 bitop3:0xa8
    v_cmp_ne_u32_e64 s[14:15], 0, v32
    s_quadmask_b64 s[8:9], s[8:9]
    s_bitreplicate_b64_b32 s[8:9], s8
    s_wqm_b32 s8, s8
    s_bitreplicate_b64_b32 s[40:41], s8
    s_quadmask_b64 s[10:11], s[10:11]
    s_bitreplicate_b64_b32 s[10:11], s10
    s_wqm_b32 s10, s10
    s_bitreplicate_b64_b32 s[42:43], s10
    s_quadmask_b64 s[12:13], s[12:13]
    s_bitreplicate_b64_b32 s[12:13], s12
    s_wqm_b32 s12, s12
    s_bitreplicate_b64_b32 s[52:53], s12
    s_quadmask_b64 s[14:15], s[14:15]
    s_bitreplicate_b64_b32 s[14:15], s14
    s_wqm_b32 s14, s14
    s_bitreplicate_b64_b32 s[54:55], s14
    s_mov_b64 exec, -1
    s_add_u32 s33, s33, 1
    s_cmp_lt_u32 s33, 400000
    s_cbranch_scc0 L_exit
L_fchk:
    s_waitcnt vmcnt(0)
    v_bitop3_b32 v12, v56, v57, v36 bitop3:0x7e
    v_bitop3_b32 v13, v58, v59, v37 bitop3:0x7e
    v_bitop3_b32 v14, v60, v61, v36 bitop3:0x7e
    v_bitop3_b32 v15, v62, v63, v37 bitop3:0x7e
    v_bitop3_b32 v16, v64, v65, v36 bitop3:0x7e
    v_bitop3_b32 v17, v66, v67, v37 bitop3:0x7e
    v_bitop3_b32 v18, v68, v69, v36 bitop3:0x7e
    v_bitop3_b32 v19, v70, v71, v37 bitop3:0x7e
    v_or3_b32 v32, v12, v13, v14
    v_or3_b32 v33, v15, v16, v17
    v_or3_b32 v32, v32, v18, v19
    v_bitop3_b32 v32, v32, v33, s38 bitop3:0xa8
    v_cmp_ne_u32 vcc, 0, v32
    s_cbranch_vccnz L_fpoll
    v_xor_b32 v56, v36, v56
    v_xor_b32 v57, v36, v57
    v_xor_b32 v58, v37, v58
    v_xor_b32 v59, v37, v59
    v_xor_b32 v60, v36, v60
    v_xor_b32 v61, v36, v61
    v_mfma_f32_16x16x32_bf16 v[28:31], v[76:79], v[56:59], 0
    v_xor_b32 v62, v37, v62
    v_xor_b32 v63, v37, v63
    v_xor_b32 v64, v36, v64
    v_xor_b32 v65, v36, v65
    v_mfma_f32_16x16x32_bf16 v[28:31], v[76:79], v[60:63], v[28:31]
    v_xor_b32 v66, v37, v66
    v_xor_b32 v67, v37, v67
    v_xor_b32 v68, v36, v68
    v_xor_b32 v69, v36, v69
    v_mfma_f32_16x16x32_bf16 v[28:31], v[76:79], v[64:67], v[28:31]
    v_xor_b32 v70, v37, v70
    v_xor_b32 v71, v37, v71
    s_nop 1
    v_mfma_f32_16x16x32_bf16 v[28:31], v[76:79], v[68:71], v[28:31]
    s_nop 7
    v_add_f32_dpp v28, v28, v28 row_ror:8 row_mask:0xf bank_mask:0xf
    v_add_f32_dpp v29, v29, v29 row_ror:8 row_mask:0xf bank_mask:0xf
    v_add_f32_dpp v30, v30, v30 row_ror:8 row_mask:0xf bank_mask:0xf
    v_add_f32_dpp v31, v31, v31 row_ror:8 row_mask:0xf bank_mask:0xf
    v_pk_fma_f32 v[28:29], v[28:29], v[80:81], v[72:73]
    v_pk_fma_f32 v[30:31], v[30:31], v[82:83], v[74:75]
    v_cvt_pk_bf16_f32 v28, v28, v29
    v_cvt_pk_bf16_f32 v29, v30, v31
    s_mov_b64 exec, 0xff00ff
    buffer_store_dwordx2 v[28:29], v85, s[20:23], 0 offen
    s_endpgm
L_idle:
    s_or_b32 s30, s6, s29
    s_cbranch_scc1 L_exit
    s_barrier
    s_barrier
    s_mov_b32 s32, 393216
    v_and_b32 v52, 0x70, v5
    v_mov_b32 v43, s28
L_ipoll:
    buffer_load_dword v12, v52, s[16:19], s32 offen sc1
    s_waitcnt vmcnt(0)
    v_cmp_ne_u32_sdwa vcc, v12, v11 src0_sel:BYTE_0 src1_sel:DWORD
    s_cbranch_vccz L_igot
    s_add_u32 s33, s33, 1
    s_cmp_lt_u32 s33, 400000
    s_cbranch_scc1 L_ipoll
    s_branch L_exit
L_igot:
    s_mov_b64 exec, 1
    buffer_store_dword v43, off, s[16:19], 0 sc1
    buffer_wbl2 sc1
    s_branch L_exit
L_ffn:
    s_sub_u32 s34, s34, 4
    s_mov_b32 s8, s52
    s_mov_b32 s9, s53
    s_mov_b32 s10, 1605632
    s_mov_b32 s11, 0x20000
    s_mov_b32 s12, s54
    s_mov_b32 s13, s55
    s_mov_b32 s14, 1605632
    s_mov_b32 s15, 0x20000
    s_movk_i32 s32, 3584
    s_movk_i32 s68, 28672
    s_mov_b32 s69, 229376
    s_lshl_b32 s70, s34, 7
    v_mad_u32_u24 v9, v1, s32, v2
    v_lshrrev_b32 v12, 5, v0
    v_bfe_u32 v13, v0, 3, 1
    v_lshl_or_b32 v12, v12, 1, v13
    v_mul_u32_u24 v12, 1088, v12
    v_and_b32 v13, 16, v0
    v_lshl_add_u32 v12, v13, 3, v12
    v_and_b32 v13, 7, v0
    v_lshl_add_u32 v12, v13, 3, v12
    s_lshl_b32 s30, s29, 8
    s_add_u32 s30, s30, 16384
    v_add_u32 v3, s30, v12
    v_add_u32 v46, 64512, v3
    v_and_b32 v14, 0x70, v5
    v_lshrrev_b32 v13, 5, v0
    v_lshl_or_b32 v14, v13, 12, v14
    v_and_b32 v13, 24, v0
    v_lshl_or_b32 v48, v13, 12, v14
    v_add_u32 v13, 8, v13
    v_and_b32 v13, 32, v13
    v_lshl_or_b32 v8, v13, 25, v48
    s_lshl_b32 s73, s34, 7
    s_lshl_b32 s30, s29, 13
    s_add_u32 s73, s73, s30
    s_add_u32 s73, s73, 1572864
    s_add_u32 s20, s73, 0x20000
    v_and_b32 v13, 7, v0
    v_mul_u32_u24 v13, 3, v13
    v_lshrrev_b32 v13, v13, s28
    s_mov_b32 s38, 0x10001
    s_and_b32 s30, s28, 1
    v_bfe_u32 v36, v13, 1, 1
    v_lshl_or_b32 v36, v36, 16, s30
    v_bfe_u32 v37, v13, 2, 1
    v_bfe_u32 v13, v13, 3, 1
    v_lshl_or_b32 v37, v13, 16, v37
    v_mov_b32 v43, v36
    s_nop 0
    v_mov_b32_dpp v43, v37 quad_perm:[0,1,2,3] row_mask:0xa bank_mask:0xf
    v_mov_b32 v50, v43
    v_and_b32 v12, 7, v0
    v_lshlrev_b32 v12, 1, v12
    v_and_b32 v13, 8, v0
    v_lshl_or_b32 v12, v13, 4, v12
    v_and_b32 v13, 48, v0
    v_lshl_or_b32 v12, v13, 1, v12
    s_lshl_b32 s30, s29, 8
    v_add_u32 v49, s30, v12
    s_mov_b32 s39, 0xbfb8aa3b
    v_and_b32 v12, 1, v0
    v_mul_u32_u24 v51, 0xaaaa, v12
    v_add_u32 v51, 0x4444, v51
    v_lshlrev_b32 v12, 7, v12
    v_lshl_or_b32 v12, v13, 4, v12
    v_and_b32 v13, 14, v0
    v_lshl_or_b32 v10, v13, 3, v12
    v_mov_b32 v76, 0
    v_mov_b32 v77, 0
    v_mov_b32 v78, 0
    v_mov_b32 v79, 0
    v_mov_b32 v80, 0
    v_mov_b32 v81, 0
    v_mov_b32 v82, 0
    v_mov_b32 v83, 0
    v_mov_b32 v84, 0
    v_mov_b32 v85, 0
    v_mov_b32 v86, 0
    v_mov_b32 v87, 0
    v_mov_b32 v60, 0
    v_mov_b32 v61, 0
    v_mov_b32 v62, 0
    v_mov_b32 v63, 0
    v_mov_b32 v64, 0
    v_mov_b32 v65, 0
    v_mov_b32 v66, 0
    v_mov_b32 v67, 0
    v_mov_b32 v40, 0
    v_mov_b32 v41, 0
    v_mov_b32 v42, 0
    v_mov_b32 v43, 0
    s_mov_b32 s72, s29
    s_add_u32 s70, s70, 458752
    s_waitcnt vmcnt(0)
L_spin_162:
    v_mov_b32 v12, 0
    ds_read_b32 v12, v12 offset:36
    s_waitcnt lgkmcnt(0)
    v_readfirstlane_b32 s31, v12
    s_cmp_ge_u32 s31, 64
    s_cbranch_scc1 L_got_163
    s_add_u32 s33, s33, 1
    s_cmp_lt_u32 s33, 400000
    s_cbranch_scc1 L_spin_162
    s_branch L_exit
L_got_163:
    s_lshl_b32 s30, s29, 1
    s_mul_i32 s31, s30, 1088
    s_add_u32 m0, s31, 33792
    s_mul_i32 s30, s30, s68
    s_add_u32 s30, s30, s70
    s_add_u32 s31, s30, s68
    buffer_load_dwordx4 v9, s[8:11], s30 offen nt lds
    s_addk_i32 m0, 1088
    s_add_u32 s30, s30, s69
    buffer_load_dwordx4 v9, s[8:11], s31 offen nt lds
    s_addk_i32 m0, 7616
    s_add_u32 s31, s31, s69
    buffer_load_dwordx4 v9, s[8:11], s30 offen nt lds
    s_addk_i32 m0, 1088
    s_add_u32 s30, s30, s69
    buffer_load_dwordx4 v9, s[8:11], s31 offen nt lds
    s_addk_i32 m0, 7616
    s_add_u32 s31, s31, s69
    buffer_load_dwordx4 v9, s[8:11], s30 offen nt lds
    s_addk_i32 m0, 1088
    s_add_u32 s30, s30, s69
    buffer_load_dwordx4 v9, s[8:11], s31 offen nt lds
    s_addk_i32 m0, 7616
    s_add_u32 s31, s31, s69
    s_barrier
    buffer_load_dwordx4 v9, s[8:11], s30 offen nt lds
    s_addk_i32 m0, 1088
    s_add_u32 s30, s30, s69
    buffer_load_dwordx4 v9, s[8:11], s31 offen nt lds
    s_addk_i32 m0, 7616
    s_add_u32 s31, s31, s69
    buffer_load_dwordx4 v9, s[8:11], s30 offen nt lds
    s_addk_i32 m0, 1088
    s_add_u32 s30, s30, s69
    buffer_load_dwordx4 v9, s[8:11], s31 offen nt lds
    s_sub_u32 s70, s70, 458752
    s_lshl_b32 s30, s29, 1
    s_mul_i32 s31, s30, 1088
    s_add_u32 m0, s31, 80896
    s_mul_i32 s30, s30, s68
    s_add_u32 s30, s30, s70
    s_add_u32 s31, s30, s68
    buffer_load_dwordx4 v9, s[12:15], s30 offen nt lds
    s_addk_i32 m0, 1088
    s_add_u32 s30, s30, s69
    buffer_load_dwordx4 v9, s[12:15], s31 offen nt lds
    s_addk_i32 m0, 7616
    s_add_u32 s31, s31, s69
    buffer_load_dwordx4 v9, s[12:15], s30 offen nt lds
    s_addk_i32 m0, 1088
    s_add_u32 s30, s30, s69
    buffer_load_dwordx4 v9, s[12:15], s31 offen nt lds
    s_addk_i32 m0, 7616
    s_add_u32 s31, s31, s69
    buffer_load_dwordx4 v9, s[12:15], s30 offen nt lds
    s_addk_i32 m0, 1088
    s_add_u32 s30, s30, s69
    buffer_load_dwordx4 v9, s[12:15], s31 offen nt lds
    s_addk_i32 m0, 7616
    s_add_u32 s31, s31, s69
    buffer_load_dwordx4 v9, s[12:15], s30 offen nt lds
    s_addk_i32 m0, 1088
    s_add_u32 s30, s30, s69
    buffer_load_dwordx4 v9, s[12:15], s31 offen nt lds
    s_addk_i32 m0, 7616
    s_add_u32 s31, s31, s69
    buffer_load_dwordx4 v9, s[12:15], s30 offen nt lds
    s_addk_i32 m0, 1088
    s_add_u32 s30, s30, s69
    buffer_load_dwordx4 v9, s[12:15], s31 offen nt lds
    s_addk_i32 m0, 7616
    s_add_u32 s31, s31, s69
    buffer_load_dwordx4 v9, s[12:15], s30 offen nt lds
    s_addk_i32 m0, 1088
    s_add_u32 s30, s30, s69
    buffer_load_dwordx4 v9, s[12:15], s31 offen nt lds
    s_addk_i32 m0, 7616
    s_add_u32 s31, s31, s69
    buffer_load_dwordx4 v9, s[12:15], s30 offen nt lds
    s_addk_i32 m0, 1088
    s_add_u32 s30, s30, s69
    buffer_load_dwordx4 v9, s[12:15], s31 offen nt lds
    s_waitcnt vmcnt(14)
    v_mov_b32 v12, 0
    v_mov_b32 v13, 1
    s_mov_b64 exec, 1
    ds_add_u32 v12, v13 offset:28
    s_mov_b64 exec, -1
L_spin_164:
    v_mov_b32 v12, 0
    ds_read_b32 v12, v12 offset:28
    s_waitcnt lgkmcnt(0)
    v_readfirstlane_b32 s31, v12
    s_cmp_ge_u32 s31, 8
    s_cbranch_scc1 L_got_165
    s_add_u32 s33, s33, 1
    s_cmp_lt_u32 s33, 400000
    s_cbranch_scc1 L_spin_164
    s_branch L_exit
L_got_165:
    ds_read_b64_tr_b16 v[144:145], v3 offset:0
    ds_read_b64_tr_b16 v[146:147], v3 offset:64
    ds_read_b64_tr_b16 v[148:149], v3 offset:4352
    ds_read_b64_tr_b16 v[150:151], v3 offset:4416
    ds_read_b64_tr_b16 v[152:153], v3 offset:8704
    ds_read_b64_tr_b16 v[154:155], v3 offset:8768
    ds_read_b64_tr_b16 v[156:157], v3 offset:13056
    ds_read_b64_tr_b16 v[158:159], v3 offset:13120
    ds_read_b64_tr_b16 v[160:161], v3 offset:17408
    ds_read_b64_tr_b16 v[162:163], v3 offset:17472
    ds_read_b64_tr_b16 v[164:165], v3 offset:21760
    ds_read_b64_tr_b16 v[166:167], v3 offset:21824
    ds_read_b64_tr_b16 v[168:169], v3 offset:26112
    ds_read_b64_tr_b16 v[170:171], v3 offset:26176
    ds_read_b64_tr_b16 v[172:173], v3 offset:30464
    ds_read_b64_tr_b16 v[174:175], v3 offset:30528
    ds_read_b64_tr_b16 v[176:177], v3 offset:34816
    ds_read_b64_tr_b16 v[178:179], v3 offset:34880
    ds_read_b64_tr_b16 v[180:181], v3 offset:39168
    ds_read_b64_tr_b16 v[182:183], v3 offset:39232
    ds_read_b64_tr_b16 v[184:185], v3 offset:43520
    ds_read_b64_tr_b16 v[186:187], v3 offset:43584
    ds_read_b64_tr_b16 v[188:189], v3 offset:47872
    ds_read_b64_tr_b16 v[190:191], v3 offset:47936
    ds_read_b64_tr_b16 v[192:193], v3 offset:52224
    ds_read_b64_tr_b16 v[194:195], v3 offset:52288
    ds_read_b64_tr_b16 v[196:197], v3 offset:56576
    ds_read_b64_tr_b16 v[198:199], v3 offset:56640
    s_waitcnt vmcnt(0)
    v_mov_b32 v12, 0
    v_mov_b32 v13, 1
    s_mov_b64 exec, 1
    ds_add_u32 v12, v13 offset:32
    s_mov_b64 exec, -1
L_spin_166:
    v_mov_b32 v12, 0
    ds_read_b32 v12, v12 offset:32
    s_waitcnt lgkmcnt(0)
    v_readfirstlane_b32 s31, v12
    s_cmp_ge_u32 s31, 4
    s_cbranch_scc1 L_got_167
    s_add_u32 s33, s33, 1
    s_cmp_lt_u32 s33, 400000
    s_cbranch_scc1 L_spin_166
    s_branch L_exit
L_got_167:
    ds_read_b64_tr_b16 v[200:201], v46 offset:0
    ds_read_b64_tr_b16 v[202:203], v46 offset:64
    ds_read_b64_tr_b16 v[204:205], v46 offset:4352
    ds_read_b64_tr_b16 v[206:207], v46 offset:4416
    ds_read_b64_tr_b16 v[208:209], v46 offset:8704
    ds_read_b64_tr_b16 v[210:211], v46 offset:8768
    ds_read_b64_tr_b16 v[212:213], v46 offset:13056
    ds_read_b64_tr_b16 v[214:215], v46 offset:13120
    ds_read_b64_tr_b16 v[216:217], v46 offset:17408
    ds_read_b64_tr_b16 v[218:219], v46 offset:17472
    ds_read_b64_tr_b16 v[220:221], v46 offset:21760
    ds_read_b64_tr_b16 v[222:223], v46 offset:21824
    ds_read_b64_tr_b16 v[224:225], v46 offset:26112
    ds_read_b64_tr_b16 v[226:227], v46 offset:26176
    ds_read_b64_tr_b16 v[228:229], v46 offset:30464
    ds_read_b64_tr_b16 v[230:231], v46 offset:30528
    ds_read_b64_tr_b16 v[232:233], v46 offset:34816
    ds_read_b64_tr_b16 v[234:235], v46 offset:34880
    ds_read_b64_tr_b16 v[236:237], v46 offset:39168
    ds_read_b64_tr_b16 v[238:239], v46 offset:39232
    ds_read_b64_tr_b16 v[240:241], v46 offset:43520
    ds_read_b64_tr_b16 v[242:243], v46 offset:43584
    ds_read_b64_tr_b16 v[244:245], v46 offset:47872
    ds_read_b64_tr_b16 v[246:247], v46 offset:47936
    ds_read_b64_tr_b16 v[248:249], v46 offset:52224
    ds_read_b64_tr_b16 v[250:251], v46 offset:52288
    ds_read_b64_tr_b16 v[252:253], v46 offset:56576
    ds_read_b64_tr_b16 v[254:255], v46 offset:56640
    s_branch L_ln
L_fhelp:
    s_mov_b64 exec, -1
    s_add_u32 s72, s3, 4
    v_lshlrev_b32 v5, 4, v0
    v_lshrrev_b32 v12, 3, v0
    v_and_b32 v13, 0x70, v5
    v_lshl_or_b32 v7, v12, 8, v13
    v_mov_b32 v11, v9
L_spin_168:
    v_mov_b32 v12, 0
    ds_read_b32 v12, v12 offset:32
    s_waitcnt lgkmcnt(0)
    v_readfirstlane_b32 s31, v12
    s_cmp_ge_u32 s31, 4
    s_cbranch_scc1 L_got_169
    s_add_u32 s33, s33, 1
    s_cmp_lt_u32 s33, 400000
    s_cbranch_scc1 L_spin_168
    s_branch L_exit
L_got_169:
    s_lshl_b32 s30, s3, 12
    s_add_u32 s30, s30, 146432
    v_add_u32 v12, s30, v5
    ds_read_b128 v[52:55], v12 offset:0
    ds_read_b128 v[56:59], v12 offset:1024
    ds_read_b128 v[68:71], v12 offset:2048
    ds_read_b128 v[72:75], v12 offset:3072
L_ln:
    s_lshl_b32 s24, s72, 11
    s_add_u32 s24, s24, 393216
    s_lshl_b32 s31, s4, 14
    s_add_u32 s24, s24, s31
    v_and_b32 v12, 7, v0
    v_and_b32 v13, 32, v0
    v_lshlrev_b32 v13, 3, v13
    v_lshl_or_b32 v45, v12, 5, v13
    s_lshl_b32 s30, s72, 2
    v_add_u32 v47, s30, v45
    s_lshl_b32 s30, s72, 10
    v_add_u32 v44, s30, v5
    s_waitcnt lgkmcnt(0)
    buffer_load_dwordx4 v[12:15], v7, s[16:19], s24 offen offset:0 sc1
    buffer_load_dwordx4 v[16:19], v7, s[16:19], s24 offen offset:128 sc1
    s_mov_b64 s[12:13], -1
    s_mov_b64 s[14:15], -1
    s_branch L_xchk
L_xpoll:
    s_mov_b64 exec, s[12:13]
    buffer_load_dwordx4 v[12:15], v7, s[16:19], s24 offen offset:0 sc1
    s_mov_b64 exec, s[14:15]
    buffer_load_dwordx4 v[16:19], v7, s[16:19], s24 offen offset:128 sc1
    s_quadmask_b64 s[8:9], s[8:9]
    s_bitreplicate_b64_b32 s[8:9], s8
    s_wqm_b32 s8, s8
    s_bitreplicate_b64_b32 s[12:13], s8
    s_quadmask_b64 s[10:11], s[10:11]
    s_bitreplicate_b64_b32 s[10:11], s10
    s_wqm_b32 s10, s10
    s_bitreplicate_b64_b32 s[14:15], s10
    s_mov_b64 exec, -1
    s_add_u32 s33, s33, 1
    s_cmp_lt_u32 s33, 400000
    s_cbranch_scc0 L_exit
L_xchk:
    s_waitcnt vmcnt(0)
    v_cmp_ne_u32_sdwa s[8:9], v12, v11 src0_sel:BYTE_0 src1_sel:DWORD
    v_cmp_ne_u32_sdwa s[10:11], v16, v11 src0_sel:BYTE_0 src1_sel:DWORD
    s_or_b64 vcc, s[8:9], s[10:11]
    s_cbranch_scc1 L_xpoll
    v_xor_b32 v12, v11, v12
    v_xor_b32 v16, v11, v16
    v_pk_mul_f32 v[30:31], v[14:15], v[14:15]
    v_pk_add_f32 v[28:29], v[14:15], v[18:19]
    v_pk_mul_f32 v[34:35], v[12:13], v[12:13]
    v_pk_add_f32 v[32:33], v[12:13], v[16:17]
    v_pk_fma_f32 v[30:31], v[18:19], v[18:19], v[30:31]
    v_pk_fma_f32 v[34:35], v[16:17], v[16:17], v[34:35]
    v_pk_add_f32 v[28:29], v[28:29], v[32:33]
    v_pk_add_f32 v[30:31], v[30:31], v[34:35]
    v_add_f32 v28, v28, v29
    v_add_f32 v30, v30, v31
    s_nop 1
    v_permlane32_swap_b32 v28, v30
    v_add_f32 v28, v28, v30
    v_mov_b32 v30, v28
    s_nop 1
    v_permlane16_swap_b32 v28, v30
    v_add_f32 v28, v28, v30
    s_nop 1
    v_add_f32_dpp v28, v28, v28 row_ror:8 row_mask:0xf bank_mask:0xf
    ds_write_b32 v47, v28 offset:512
    s_waitcnt lgkmcnt(0)
    s_barrier
    ds_read_b128 v[28:31], v45 offset:512
    ds_read_b128 v[32:35], v45 offset:528
    s_waitcnt lgkmcnt(0)
    v_pk_add_f32 v[28:29], v[28:29], v[30:31]
    v_pk_add_f32 v[32:33], v[32:33], v[34:35]
    v_pk_add_f32 v[28:29], v[28:29], v[32:33]
    v_add_f32 v29, v28, v29
    v_mul_f32 v28, 0x3b124925, v29
    v_mul_f32 v30, 0x3b124925, v29
    s_nop 1
    v_permlane32_swap_b32 v28, v30
    v_fma_f32 v30, -v28, v28, v30
    v_cvt_pk_bf16_f32 v28, 0, v28
    v_max_f32 v30, 0, v30
    v_cvt_pk_bf16_f32 v30, 0, v30
    v_pk_add_f32 v[12:13], v[12:13], v[28:29] op_sel_hi:[1,0] neg_lo:[0,1] neg_hi:[0,1]
    v_add_f32 v30, 0x3727c5ac, v30
    v_pk_add_f32 v[14:15], v[14:15], v[28:29] op_sel_hi:[1,0] neg_lo:[0,1] neg_hi:[0,1]
    v_cvt_pk_bf16_f32 v30, 0, v30
    v_pk_add_f32 v[16:17], v[16:17], v[28:29] op_sel_hi:[1,0] neg_lo:[0,1] neg_hi:[0,1]
    v_sqrt_f32 v30, v30
    v_pk_add_f32 v[18:19], v[18:19], v[28:29] op_sel_hi:[1,0] neg_lo:[0,1] neg_hi:[0,1]
    v_cvt_pk_bf16_f32 v30, 0, v30
    v_pk_mul_f32 v[12:13], v[12:13], v[68:69]
    v_rcp_f32 v30, v30
    v_pk_mul_f32 v[14:15], v[14:15], v[70:71]
    v_pk_mul_f32 v[16:17], v[16:17], v[72:73]
    v_pk_mul_f32 v[18:19], v[18:19], v[74:75]
    v_pk_fma_f32 v[12:13], v[12:13], v[30:31], v[52:53] op_sel_hi:[1,0,1]
    v_pk_fma_f32 v[14:15], v[14:15], v[30:31], v[54:55] op_sel_hi:[1,0,1]
    v_pk_fma_f32 v[16:17], v[16:17], v[30:31], v[56:57] op_sel_hi:[1,0,1]
    v_pk_fma_f32 v[18:19], v[18:19], v[30:31], v[58:59] op_sel_hi:[1,0,1]
    v_cvt_pk_bf16_f32 v12, v12, v13
    v_cvt_pk_bf16_f32 v13, v14, v15
    v_cvt_pk_bf16_f32 v14, v16, v17
    v_cvt_pk_bf16_f32 v15, v18, v19
    ds_write_b128 v44, v[12:15] offset:8192
    s_cmp_lt_u32 s3, 4
    s_cbranch_scc1 L_fhx
    s_waitcnt lgkmcnt(0)
    s_barrier
    ds_read_b128 v[12:15], v10 offset:8192
    ds_read_b128 v[16:19], v10 offset:9216
    ds_read_b128 v[20:23], v10 offset:10240
    ds_read_b128 v[24:27], v10 offset:11264
    ds_read_b128 v[28:31], v10 offset:12288
    ds_read_b128 v[32:35], v10 offset:13312
    ds_read_b128 v[36:39], v10 offset:14336
    s_waitcnt lgkmcnt(6)
    v_smfmac_f32_16x16x64_bf16 v[76:79], v[12:15], v[144:151], v51
    s_waitcnt lgkmcnt(5)
    v_smfmac_f32_16x16x64_bf16 v[76:79], v[16:19], v[152:159], v51
    s_waitcnt lgkmcnt(4)
    v_smfmac_f32_16x16x64_bf16 v[76:79], v[20:23], v[160:167], v51
    s_waitcnt lgkmcnt(3)
    v_smfmac_f32_16x16x64_bf16 v[76:79], v[24:27], v[168:175], v51
    s_waitcnt lgkmcnt(2)
    v_smfmac_f32_16x16x64_bf16 v[76:79], v[28:31], v[176:183], v51
    s_waitcnt lgkmcnt(1)
    v_smfmac_f32_16x16x64_bf16 v[76:79], v[32:35], v[184:191], v51
    s_waitcnt lgkmcnt(0)
    v_smfmac_f32_16x16x64_bf16 v[76:79], v[36:39], v[192:199], v51
    v_smfmac_f32_16x16x64_bf16 v[80:83], v[12:15], v[200:207], v51
    s_nop 1
    v_smfmac_f32_16x16x64_bf16 v[80:83], v[16:19], v[208:215], v51
    s_nop 2
    v_smfmac_f32_16x16x64_bf16 v[80:83], v[20:23], v[216:223], v51
    v_add_f32 v76, v76, v77
    v_add_f32 v77, v78, v79
    v_smfmac_f32_16x16x64_bf16 v[80:83], v[24:27], v[224:231], v51
    v_cvt_pk_bf16_f32 v76, 0, v76
    v_cvt_pk_bf16_f32 v77, 0, v77
    v_smfmac_f32_16x16x64_bf16 v[80:83], v[28:31], v[232:239], v51
    v_mul_f32 v78, s39, v76
    v_mul_f32 v79, s39, v77
    v_smfmac_f32_16x16x64_bf16 v[80:83], v[32:35], v[240:247], v51
    v_exp_f32 v78, v78
    v_smfmac_f32_16x16x64_bf16 v[80:83], v[36:39], v[248:255], v51
    v_exp_f32 v79, v79
    v_add_f32 v78, 1.0, v78
    v_add_f32 v79, 1.0, v79
    v_rcp_f32 v78, v78
    v_rcp_f32 v79, v79
    v_mul_f32 v78, v78, v76
    v_mul_f32 v79, v79, v77
    v_cvt_pk_bf16_f32 v78, 0, v78
    v_add_f32 v80, v80, v81
    v_add_f32 v81, v82, v83
    v_cvt_pk_bf16_f32 v79, 0, v79
    v_cvt_pk_bf16_f32 v80, 0, v80
    v_cvt_pk_bf16_f32 v81, 0, v81
    v_pk_mul_f32 v[12:13], v[78:79], v[80:81]
    v_cvt_pk_bf16_f32 v12, v12, v13
    ds_write_b16 v49, v12 offset:15360
    ds_write_b16_d16_hi v49, v12 offset:15376
    s_waitcnt lgkmcnt(0)
    s_barrier
    s_mov_b64 exec, s[36:37]
    ds_read_b128 v[60:63], v4 offset:15360
    ds_read_b128 v[64:67], v4 offset:15872
    s_not_b64 exec, exec
    ds_read_b128 v[84:87], v4 offset:15360
    ds_read_b128 v[40:43], v4 offset:15872
    s_mov_b64 exec, -1
    s_waitcnt lgkmcnt(3)
    v_mfma_f32_16x16x32_bf16 v[12:15], v[88:91], v[60:63], 0
    s_waitcnt lgkmcnt(2)
    v_mfma_f32_16x16x32_bf16 v[12:15], v[92:95], v[64:67], v[12:15]
    s_waitcnt lgkmcnt(1)
    v_mfma_f32_16x16x32_bf16 v[12:15], v[96:99], v[84:87], v[12:15]
    s_waitcnt lgkmcnt(0)
    v_mfma_f32_16x16x32_bf16 v[12:15], v[100:103], v[40:43], v[12:15]
    v_mfma_f32_16x16x32_bf16 v[16:19], v[104:107], v[60:63], 0
    s_nop 1
    v_mfma_f32_16x16x32_bf16 v[16:19], v[108:111], v[64:67], v[16:19]
    s_nop 2
    v_mfma_f32_16x16x32_bf16 v[16:19], v[112:115], v[84:87], v[16:19]
    v_add_u32 v12, 0x8000, v12
    v_add_u32 v13, 0x8000, v13
    v_mfma_f32_16x16x32_bf16 v[16:19], v[116:119], v[40:43], v[16:19]
    v_add_u32 v14, 0x8000, v14
    v_add_u32 v15, 0x8000, v15
    v_mfma_f32_16x16x32_bf16 v[24:27], v[136:139], v[60:63], 0
    v_cvt_pk_bf16_f32 v29, v14, v15
    v_cvt_pk_bf16_f32 v28, v12, v13
    v_mfma_f32_16x16x32_bf16 v[24:27], v[140:143], v[64:67], v[24:27]
    v_bfi_b32 v29, s38, v50, v29
    v_bfi_b32 v28, s38, v50, v28
    v_mfma_f32_16x16x32_bf16 v[20:23], v[120:123], v[60:63], 0
    v_add_u32 v16, 0x8000, v16
    v_add_u32 v17, 0x8000, v17
    v_add_u32 v18, 0x8000, v18
    v_mfma_f32_16x16x32_bf16 v[20:23], v[124:127], v[64:67], v[20:23]
    v_add_u32 v19, 0x8000, v19
    v_cvt_pk_bf16_f32 v31, v18, v19
    v_cvt_pk_bf16_f32 v30, v16, v17
    v_mfma_f32_16x16x32_bf16 v[20:23], v[128:131], v[84:87], v[20:23]
    v_bfi_b32 v31, s38, v50, v31
    v_bfi_b32 v30, s38, v50, v30
    v_add_u32 v24, 0x8000, v24
    v_mfma_f32_16x16x32_bf16 v[20:23], v[132:135], v[40:43], v[20:23]
    v_permlane16_swap_b32 v29, v31
    v_permlane16_swap_b32 v28, v30
    buffer_store_dwordx4 v[28:31], v48, s[16:19], s73 offen sc1
    v_add_u32 v25, 0x8000, v25
    v_add_u32 v26, 0x8000, v26
    v_add_u32 v27, 0x8000, v27
    v_cvt_pk_bf16_f32 v35, v26, v27
    v_cvt_pk_bf16_f32 v34, v24, v25
    v_bfi_b32 v35, s38, v50, v35
    v_bfi_b32 v34, s38, v50, v34
    v_add_u32 v20, 0x8000, v20
    v_add_u32 v21, 0x8000, v21
    v_add_u32 v22, 0x8000, v22
    v_add_u32 v23, 0x8000, v23
    v_cvt_pk_bf16_f32 v33, v22, v23
    v_cvt_pk_bf16_f32 v32, v20, v21
    v_bfi_b32 v33, s38, v50, v33
    v_bfi_b32 v32, s38, v50, v32
    s_nop 0
    v_permlane16_swap_b32 v33, v35
    v_permlane16_swap_b32 v32, v34
    buffer_store_dwordx4 v[32:35], v8, s[16:19], s20 offen sc1
    s_endpgm
L_fhx:
    s_waitcnt lgkmcnt(0)
    s_barrier
    s_barrier
L_exit:
L_end:
    s_endpgm
.section .rodata,"a"
.p2align 6
.amdhsa_kernel adaLN_cond__sliding_block_cached__glu_gated_swiglu__decode_kernel
.amdhsa_next_free_vgpr 256
.amdhsa_next_free_sgpr 102
.amdhsa_accum_offset 256
.amdhsa_group_segment_fixed_size 0
.amdhsa_kernarg_size 112
.amdhsa_user_sgpr_count 2
.amdhsa_user_sgpr_kernarg_segment_ptr 1
.amdhsa_system_sgpr_workgroup_id_x 1
.amdhsa_float_denorm_mode_32 3
.end_amdhsa_kernel
```
